```python
import torch

def _softmax(x, axis=-1):
    return torch.softmax(x, dim=axis)
def _gelu(x):
    return torch.nn.functional.gelu(x, approximate="tanh")
def _silu(x):
    return torch.nn.functional.silu(x)
def _sigmoid(x):
    return torch.sigmoid(x)
def _layernorm(x, axis=-1, eps=1e-5):
    m = x.mean(dim=axis, keepdim=True)
    v = x.var(dim=axis, keepdim=True, unbiased=False)
    return (x - m) / torch.sqrt(v + eps)
def _scatter_add(tgt, idx, src, axis=0):
    return tgt.clone().index_add_(axis, idx, src)
def _segment_sum(src, seg, n):
    out = torch.zeros((n,) + src.shape[1:], dtype=src.dtype)
    return out.index_add_(0, seg, src)
def _pad(x, pw):
    flat = tuple(v for pair in reversed(pw) for v in pair)
    return torch.nn.functional.pad(x, flat)

kernel_name = 'gated_mix__compressed_kv_cla__dense_activation_relu__prompt'

def setup_inputs():

    _w = (lambda a: (lambda t: t.to(torch.bfloat16) if t.is_floating_point() else t)(torch.as_tensor(a)))
    def _A_setup():
        B, H, Sq, Sk, D, M = 1, 32, 2048, 2048, 128, 576
        Dc = 4 * D
        return {
            "x": _w((lambda *s: torch.randn(*s, dtype=torch.bfloat16) * 0.05)(B, Sq, M)),
            "c_kv": _w((lambda *s: torch.randn(*s, dtype=torch.bfloat16) * 0.8)(B, Sk, Dc)),
            "w_q": _w((lambda *s: torch.randn(*s, dtype=torch.bfloat16) * 6.4)(M, H, D) * (M ** -0.5)),
            "w_uk": _w((lambda *s: torch.randn(*s, dtype=torch.bfloat16) * 6.4)(Dc, H, D) * (Dc ** -0.5)),
            "w_uv": _w((lambda *s: torch.randn(*s, dtype=torch.bfloat16) * 0.8)(Dc, H, D) * (Dc ** -0.5)),
            "w_o": _w((lambda *s: torch.randn(*s, dtype=torch.bfloat16) * 0.8)(H, D, M) * ((H * D) ** -0.5)),
        }
    _A_in = _A_setup()

    def _B_setup():
        B, S, D, Dff = 1, 2048, 576, 4608
        return {
            "x": _w((lambda *s: torch.randn(*s, dtype=torch.bfloat16) * 0.05)(B, S, D)),
            "w1": _w((lambda *s: torch.randn(*s, dtype=torch.bfloat16) * 0.05)(D, Dff)),
            "w2": _w((lambda *s: torch.randn(*s, dtype=torch.bfloat16) * 0.05)(Dff, D)),
        }
    _B_in = _B_setup()

    return {
        "A_x": _A_in["x"],
        "A_c_kv": _A_in["c_kv"],
        "A_w_q": _A_in["w_q"],
        "A_w_uk": _A_in["w_uk"],
        "A_w_uv": _A_in["w_uv"],
        "A_w_o": _A_in["w_o"],
        "B_x": _B_in["x"],
        "B_w1": _B_in["w1"],
        "B_w2": _B_in["w2"],
        "gate_w": _w((lambda *s: torch.randn(*s, dtype=torch.bfloat16) * 0.05)(576) * 16.0),
    }

def reference(A_x, A_c_kv, A_w_q, A_w_uk, A_w_uv, A_w_o, B_x, B_w1, B_w2, gate_w):
    def _A_ref(x, c_kv, w_q, w_uk, w_uv, w_o):
        B, Sq, M = x.shape[0], x.shape[1], x.shape[2]
        Sk = c_kv.shape[1]
        H, D = w_q.shape[1], w_q.shape[2]
        q = torch.einsum("bqm,mhd->bhqd", x, w_q)
        k = torch.einsum("bkc,chd->bhkd", c_kv, w_uk)
        v = torch.einsum("bkc,chd->bhkd", c_kv, w_uv)
        scores = torch.einsum("bhqd,bhkd->bhqk", q, k) * (D ** -0.5)
        off = Sk - Sq
        qi = torch.arange(Sq)[:, None]
        kj = torch.arange(Sk)[None, :]
        cmask = kj <= (qi + off)
        scores = torch.where(cmask[None, None], scores, -1e9)
        p = _softmax(scores, axis=-1)
        ctx = torch.einsum("bhqk,bhkd->bhqd", p, v)
        return torch.einsum("bhqd,hdm->bqm", ctx, w_o)

    def _B_ref(x, w1, w2):
        h = torch.einsum("bsd,df->bsf", x, w1)
        zero = torch.zeros_like(h)
        h = torch.maximum(h, zero)
        return torch.einsum("bsf,fd->bsd", h, w2)

    x = A_x
    g = _sigmoid((x * gate_w).sum(-1, keepdims=True))
    a = _A_ref(x, A_c_kv, A_w_q, A_w_uk, A_w_uv, A_w_o)
    b = _B_ref(x, B_w1, B_w2)
    return g * a + (1 - g) * b
```

```asm
; @launch kernel=k1_kernel grid=(2176,1,1) block=(256,1,1) lds=65536
; @launch kernel=k2_kernel grid=(512,1,1) block=(256,1,1) lds=65536
; @launch kernel=k3_kernel grid=(240,1,1) block=(256,1,1) lds=81920
; @launch kernel=k4_kernel grid=(512,1,1) block=(256,1,1) lds=0
.amdgcn_target "amdgcn-amd-amdhsa--gfx950"
.text
.globl k1_kernel
.p2align 8
.type k1_kernel,@function
k1_kernel:
    s_cmp_ge_u32 s2, 2176
    s_cbranch_scc1 k1_kernel_end
    s_load_dwordx2 s[26:27], s[0:1], 0
    s_load_dwordx2 s[28:29], s[0:1], 8
    s_load_dwordx2 s[32:33], s[0:1], 96
    s_and_b32 s34, s2, 7
    s_lshr_b32 s35, s2, 3
    s_lshr_b32 s37, s35, 4
    s_and_b32 s35, s35, 15
    s_lshl_b32 s37, s37, 3
    s_add_u32 s34, s34, s37
    s_cmp_ge_u32 s34, 132
    s_cbranch_scc1 k1_kernel_end
    s_lshr_b32 s36, s34, 5
    s_cmp_ge_u32 s34, 96
    s_cselect_b32 s36, 3, s36
    s_lshl_b32 s37, s36, 3
    s_add_u32 s37, s37, 16
    s_cmp_eq_u32 s36, 3
    s_cselect_b32 s37, 56, s37
    s_load_dwordx2 s[30:31], s[0:1], s37
    s_mul_i32 s38, s36, 32
    s_sub_u32 s38, s34, s38
    s_cmp_eq_u32 s36, 0
    s_cselect_b32 s39, 1, 0
    s_cmp_eq_u32 s36, 3
    s_cselect_b32 s39, 1, s39
    s_waitcnt lgkmcnt(0)
    s_cmp_eq_u32 s39, 1
    s_cselect_b32 s4, s26, s28
    s_cselect_b32 s5, s27, s29
    s_mov_b32 s41, 2097152
    s_cselect_b32 s6, 2359296, s41
    s_mov_b32 s7, 0x00020000
    s_mov_b32 s41, 1024
    s_cselect_b32 s19, 1152, s41
    s_cselect_b32 s18, 9, 8
    s_mov_b32 s8, s30
    s_mov_b32 s9, s31
    s_cmp_eq_u32 s36, 3
    s_mov_b32 s41, 8192
    s_cselect_b32 s20, 9216, s41
    s_mul_i32 s10, s18, 64
    s_mul_i32 s10, s10, s20
    s_mov_b32 s11, 0x00020000
    s_lshl_b32 s23, s20, 6
    s_mov_b32 s40, 0
    s_cmp_eq_u32 s36, 1
    s_cselect_b32 s40, 16777216, s40
    s_cmp_eq_u32 s36, 2
    s_cselect_b32 s40, 33554432, s40
    s_cmp_eq_u32 s36, 3
    s_cselect_b32 s40, 50331648, s40
    s_add_u32 s12, s32, s40
    s_addc_u32 s13, s33, 0
    s_cmp_eq_u32 s36, 3
    s_mov_b32 s41, 16777216
    s_cselect_b32 s14, 18874368, s41
    s_mov_b32 s15, 0x00020000
    s_mov_b32 s21, s20
    s_cselect_b32 s24, 0, 0xff800000
    s_mul_i32 s16, s35, 128
    s_mul_i32 s16, s16, s19
    s_mul_i32 s17, s38, 256
    s_mul_i32 s28, s35, 128
    s_mul_i32 s28, s28, s21
    s_add_u32 s28, s28, s17
    s_cmp_eq_u32 s36, 2
    s_cbranch_scc0 k1_kernel_notT
    s_movk_i32 s21, 4096
    s_mul_i32 s28, s38, 524288
    s_mul_i32 s25, s35, 256
    s_add_u32 s28, s28, s25
k1_kernel_notT:
    v_and_b32 v1, 63, v0
    v_lshrrev_b32 v2, 6, v0
    s_nop 0
    v_readfirstlane_b32 s22, v2
    v_lshrrev_b32 v3, 3, v1
    v_mul_u32_u24 v4, 32, v2
    v_add_u32 v3, v3, v4
    v_and_b32 v4, 7, v1
    v_add_u32 v5, 0, v3
    v_lshrrev_b32 v6, 1, v5
    v_and_b32 v6, 7, v6
    v_xor_b32 v6, v4, v6
    v_mul_lo_u32 v5, v5, s19
    v_lshl_add_u32 v8, v6, 4, v5
    v_add_u32 v5, 8, v3
    v_lshrrev_b32 v6, 1, v5
    v_and_b32 v6, 7, v6
    v_xor_b32 v6, v4, v6
    v_mul_lo_u32 v5, v5, s19
    v_lshl_add_u32 v9, v6, 4, v5
    v_add_u32 v5, 16, v3
    v_lshrrev_b32 v6, 1, v5
    v_and_b32 v6, 7, v6
    v_xor_b32 v6, v4, v6
    v_mul_lo_u32 v5, v5, s19
    v_lshl_add_u32 v10, v6, 4, v5
    v_add_u32 v5, 24, v3
    v_lshrrev_b32 v6, 1, v5
    v_and_b32 v6, 7, v6
    v_xor_b32 v6, v4, v6
    v_mul_lo_u32 v5, v5, s19
    v_lshl_add_u32 v11, v6, 4, v5
    v_lshrrev_b32 v3, 4, v1
    v_and_b32 v4, 15, v1
    v_lshrrev_b32 v5, 2, v4
    v_xor_b32 v5, v5, v3
    v_and_b32 v4, 3, v4
    v_lshl_add_u32 v4, v5, 2, v4
    v_lshl_add_u32 v3, v2, 4, v3
    v_mul_lo_u32 v5, v3, s20
    v_lshl_add_u32 v12, v4, 4, v5
    s_lshl_b32 s25, s20, 2
    v_add_u32 v13, s25, v12
    v_add_u32 v14, s25, v13
    v_add_u32 v15, s25, v14
    v_and_b32 v3, 31, v1
    v_lshrrev_b32 v4, 1, v2
    v_mul_u32_u24 v4, 64, v4
    v_add_u32 v3, v3, v4
    v_lshrrev_b32 v5, 5, v1
    v_lshrrev_b32 v6, 1, v3
    v_and_b32 v6, 7, v6
    v_lshlrev_b32 v7, 7, v3
    v_add_u32 v28, 0, v5
    v_xor_b32 v28, v28, v6
    v_lshl_add_u32 v16, v28, 4, v7
    v_add_u32 v28, 2, v5
    v_xor_b32 v28, v28, v6
    v_lshl_add_u32 v17, v28, 4, v7
    v_add_u32 v28, 4, v5
    v_xor_b32 v28, v28, v6
    v_lshl_add_u32 v18, v28, 4, v7
    v_add_u32 v28, 6, v5
    v_xor_b32 v28, v28, v6
    v_lshl_add_u32 v19, v28, 4, v7
    v_and_b32 v3, 15, v1
    v_lshrrev_b32 v4, 2, v3
    v_lshl_add_u32 v6, v5, 3, v4
    v_mul_u32_u24 v6, 256, v6
    v_and_b32 v7, 3, v3
    v_lshl_add_u32 v6, v7, 3, v6
    v_lshrrev_b32 v7, 4, v1
    v_and_b32 v7, 1, v7
    v_lshl_add_u32 v6, v7, 5, v6
    v_add_u32 v6, 16384, v6
    v_and_b32 v7, 1, v2
    v_mul_u32_u24 v7, 2, v7
    v_add_u32 v28, 0, v7
    v_xor_b32 v28, v28, v4
    v_lshl_add_u32 v24, v28, 6, v6
    v_add_u32 v28, 1, v7
    v_xor_b32 v28, v28, v4
    v_lshl_add_u32 v25, v28, 6, v6
    v_add_u32 v20, 32768, v16
    v_add_u32 v21, 32768, v17
    v_add_u32 v22, 32768, v18
    v_add_u32 v23, 32768, v19
    v_add_u32 v26, 32768, v24
    v_add_u32 v27, 32768, v25
    v_mov_b32 v60, 0
    v_mov_b32 v61, 0
    v_mov_b32 v62, 0
    v_mov_b32 v63, 0
    v_mov_b32 v64, 0
    v_mov_b32 v65, 0
    v_mov_b32 v66, 0
    v_mov_b32 v67, 0
    v_mov_b32 v68, 0
    v_mov_b32 v69, 0
    v_mov_b32 v70, 0
    v_mov_b32 v71, 0
    v_mov_b32 v72, 0
    v_mov_b32 v73, 0
    v_mov_b32 v74, 0
    v_mov_b32 v75, 0
    v_mov_b32 v76, 0
    v_mov_b32 v77, 0
    v_mov_b32 v78, 0
    v_mov_b32 v79, 0
    v_mov_b32 v80, 0
    v_mov_b32 v81, 0
    v_mov_b32 v82, 0
    v_mov_b32 v83, 0
    v_mov_b32 v84, 0
    v_mov_b32 v85, 0
    v_mov_b32 v86, 0
    v_mov_b32 v87, 0
    v_mov_b32 v88, 0
    v_mov_b32 v89, 0
    v_mov_b32 v90, 0
    v_mov_b32 v91, 0
    v_mov_b32 v92, 0
    v_mov_b32 v93, 0
    v_mov_b32 v94, 0
    v_mov_b32 v95, 0
    v_mov_b32 v96, 0
    v_mov_b32 v97, 0
    v_mov_b32 v98, 0
    v_mov_b32 v99, 0
    v_mov_b32 v100, 0
    v_mov_b32 v101, 0
    v_mov_b32 v102, 0
    v_mov_b32 v103, 0
    v_mov_b32 v104, 0
    v_mov_b32 v105, 0
    v_mov_b32 v106, 0
    v_mov_b32 v107, 0
    v_mov_b32 v108, 0
    v_mov_b32 v109, 0
    v_mov_b32 v110, 0
    v_mov_b32 v111, 0
    v_mov_b32 v112, 0
    v_mov_b32 v113, 0
    v_mov_b32 v114, 0
    v_mov_b32 v115, 0
    v_mov_b32 v116, 0
    v_mov_b32 v117, 0
    v_mov_b32 v118, 0
    v_mov_b32 v119, 0
    v_mov_b32 v120, 0
    v_mov_b32 v121, 0
    v_mov_b32 v122, 0
    v_mov_b32 v123, 0
    s_mul_i32 s30, s22, 4096
    s_mul_i32 s31, s22, 4096
    s_add_u32 s31, s31, 16384
    s_cmp_eq_u32 s36, 2
    s_cbranch_scc1 k1_kernel_T
    s_mov_b32 s29, s18
    s_add_u32 m0, s30, 0
    s_nop 0
    buffer_load_dwordx4 v8, s[4:7], s16 offen lds
    s_add_u32 m0, s30, 1024
    s_nop 0
    buffer_load_dwordx4 v9, s[4:7], s16 offen lds
    s_add_u32 m0, s30, 2048
    s_nop 0
    buffer_load_dwordx4 v10, s[4:7], s16 offen lds
    s_add_u32 m0, s30, 3072
    s_nop 0
    buffer_load_dwordx4 v11, s[4:7], s16 offen lds
    s_add_u32 m0, s31, 0
    s_nop 0
    buffer_load_dwordx4 v12, s[8:11], s17 offen lds
    s_add_u32 m0, s31, 1024
    s_nop 0
    buffer_load_dwordx4 v13, s[8:11], s17 offen lds
    s_add_u32 m0, s31, 2048
    s_nop 0
    buffer_load_dwordx4 v14, s[8:11], s17 offen lds
    s_add_u32 m0, s31, 3072
    s_nop 0
    buffer_load_dwordx4 v15, s[8:11], s17 offen lds
    s_add_u32 s16, s16, 128
    s_add_u32 s17, s17, s23
    s_sub_u32 s29, s29, 1
k1_kernel_N_loop:
    s_cmp_ge_u32 s18, 2
    s_cbranch_scc1 k1_kernel_N_w0
    s_waitcnt vmcnt(0)
k1_kernel_N_w0:
    s_waitcnt vmcnt(0)
    s_barrier
    ds_read_b128 v[28:31], v16 offset:0
    ds_read_b128 v[32:35], v16 offset:4096
    ds_read_b64_tr_b16 v[44:45], v24 offset:0
    ds_read_b64_tr_b16 v[46:47], v24 offset:1024
    ds_read_b64_tr_b16 v[48:49], v25 offset:0
    ds_read_b64_tr_b16 v[50:51], v25 offset:1024
    s_cmp_eq_u32 s29, 0
    s_cbranch_scc1 k1_kernel_N_nd0
    s_add_u32 m0, s30, 32768
    s_nop 0
    buffer_load_dwordx4 v8, s[4:7], s16 offen lds
    s_add_u32 m0, s30, 33792
    s_nop 0
    buffer_load_dwordx4 v9, s[4:7], s16 offen lds
    s_add_u32 m0, s30, 34816
    s_nop 0
    buffer_load_dwordx4 v10, s[4:7], s16 offen lds
    s_add_u32 m0, s30, 35840
    s_nop 0
    buffer_load_dwordx4 v11, s[4:7], s16 offen lds
    s_add_u32 m0, s31, 32768
    s_nop 0
    buffer_load_dwordx4 v12, s[8:11], s17 offen lds
    s_add_u32 m0, s31, 33792
    s_nop 0
    buffer_load_dwordx4 v13, s[8:11], s17 offen lds
    s_add_u32 m0, s31, 34816
    s_nop 0
    buffer_load_dwordx4 v14, s[8:11], s17 offen lds
    s_add_u32 m0, s31, 35840
    s_nop 0
    buffer_load_dwordx4 v15, s[8:11], s17 offen lds
    s_add_u32 s16, s16, 128
    s_add_u32 s17, s17, s23
    s_sub_u32 s29, s29, 1
k1_kernel_N_nd0:
    ds_read_b128 v[36:39], v17 offset:0
    ds_read_b128 v[40:43], v17 offset:4096
    ds_read_b64_tr_b16 v[52:53], v24 offset:4096
    ds_read_b64_tr_b16 v[54:55], v24 offset:5120
    ds_read_b64_tr_b16 v[56:57], v25 offset:4096
    ds_read_b64_tr_b16 v[58:59], v25 offset:5120
    s_waitcnt lgkmcnt(6)
    v_mfma_f32_32x32x16_bf16 v[60:75], v[44:47], v[28:31], v[60:75]
    v_mfma_f32_32x32x16_bf16 v[76:91], v[48:51], v[28:31], v[76:91]
    v_mfma_f32_32x32x16_bf16 v[92:107], v[44:47], v[32:35], v[92:107]
    v_mfma_f32_32x32x16_bf16 v[108:123], v[48:51], v[32:35], v[108:123]
    ds_read_b128 v[28:31], v18 offset:0
    ds_read_b128 v[32:35], v18 offset:4096
    ds_read_b64_tr_b16 v[44:45], v24 offset:8192
    ds_read_b64_tr_b16 v[46:47], v24 offset:9216
    ds_read_b64_tr_b16 v[48:49], v25 offset:8192
    ds_read_b64_tr_b16 v[50:51], v25 offset:9216
    s_waitcnt lgkmcnt(6)
    v_mfma_f32_32x32x16_bf16 v[60:75], v[52:55], v[36:39], v[60:75]
    v_mfma_f32_32x32x16_bf16 v[76:91], v[56:59], v[36:39], v[76:91]
    v_mfma_f32_32x32x16_bf16 v[92:107], v[52:55], v[40:43], v[92:107]
    v_mfma_f32_32x32x16_bf16 v[108:123], v[56:59], v[40:43], v[108:123]
    ds_read_b128 v[36:39], v19 offset:0
    ds_read_b128 v[40:43], v19 offset:4096
    ds_read_b64_tr_b16 v[52:53], v24 offset:12288
    ds_read_b64_tr_b16 v[54:55], v24 offset:13312
    ds_read_b64_tr_b16 v[56:57], v25 offset:12288
    ds_read_b64_tr_b16 v[58:59], v25 offset:13312
    s_waitcnt lgkmcnt(6)
    v_mfma_f32_32x32x16_bf16 v[60:75], v[44:47], v[28:31], v[60:75]
    v_mfma_f32_32x32x16_bf16 v[76:91], v[48:51], v[28:31], v[76:91]
    v_mfma_f32_32x32x16_bf16 v[92:107], v[44:47], v[32:35], v[92:107]
    v_mfma_f32_32x32x16_bf16 v[108:123], v[48:51], v[32:35], v[108:123]
    s_waitcnt lgkmcnt(0)
    v_mfma_f32_32x32x16_bf16 v[60:75], v[52:55], v[36:39], v[60:75]
    v_mfma_f32_32x32x16_bf16 v[76:91], v[56:59], v[36:39], v[76:91]
    v_mfma_f32_32x32x16_bf16 v[92:107], v[52:55], v[40:43], v[92:107]
    v_mfma_f32_32x32x16_bf16 v[108:123], v[56:59], v[40:43], v[108:123]
    s_sub_u32 s18, s18, 1
    s_cmp_eq_u32 s18, 0
    s_cbranch_scc1 k1_kernel_N_done
    s_cmp_ge_u32 s18, 2
    s_cbranch_scc1 k1_kernel_N_w1
    s_waitcnt vmcnt(0)
k1_kernel_N_w1:
    s_waitcnt vmcnt(0)
    s_barrier
    ds_read_b128 v[28:31], v20 offset:0
    ds_read_b128 v[32:35], v20 offset:4096
    ds_read_b64_tr_b16 v[44:45], v26 offset:0
    ds_read_b64_tr_b16 v[46:47], v26 offset:1024
    ds_read_b64_tr_b16 v[48:49], v27 offset:0
    ds_read_b64_tr_b16 v[50:51], v27 offset:1024
    s_cmp_eq_u32 s29, 0
    s_cbranch_scc1 k1_kernel_N_nd1
    s_add_u32 m0, s30, 0
    s_nop 0
    buffer_load_dwordx4 v8, s[4:7], s16 offen lds
    s_add_u32 m0, s30, 1024
    s_nop 0
    buffer_load_dwordx4 v9, s[4:7], s16 offen lds
    s_add_u32 m0, s30, 2048
    s_nop 0
    buffer_load_dwordx4 v10, s[4:7], s16 offen lds
    s_add_u32 m0, s30, 3072
    s_nop 0
    buffer_load_dwordx4 v11, s[4:7], s16 offen lds
    s_add_u32 m0, s31, 0
    s_nop 0
    buffer_load_dwordx4 v12, s[8:11], s17 offen lds
    s_add_u32 m0, s31, 1024
    s_nop 0
    buffer_load_dwordx4 v13, s[8:11], s17 offen lds
    s_add_u32 m0, s31, 2048
    s_nop 0
    buffer_load_dwordx4 v14, s[8:11], s17 offen lds
    s_add_u32 m0, s31, 3072
    s_nop 0
    buffer_load_dwordx4 v15, s[8:11], s17 offen lds
    s_add_u32 s16, s16, 128
    s_add_u32 s17, s17, s23
    s_sub_u32 s29, s29, 1
k1_kernel_N_nd1:
    ds_read_b128 v[36:39], v21 offset:0
    ds_read_b128 v[40:43], v21 offset:4096
    ds_read_b64_tr_b16 v[52:53], v26 offset:4096
    ds_read_b64_tr_b16 v[54:55], v26 offset:5120
    ds_read_b64_tr_b16 v[56:57], v27 offset:4096
    ds_read_b64_tr_b16 v[58:59], v27 offset:5120
    s_waitcnt lgkmcnt(6)
    v_mfma_f32_32x32x16_bf16 v[60:75], v[44:47], v[28:31], v[60:75]
    v_mfma_f32_32x32x16_bf16 v[76:91], v[48:51], v[28:31], v[76:91]
    v_mfma_f32_32x32x16_bf16 v[92:107], v[44:47], v[32:35], v[92:107]
    v_mfma_f32_32x32x16_bf16 v[108:123], v[48:51], v[32:35], v[108:123]
    ds_read_b128 v[28:31], v22 offset:0
    ds_read_b128 v[32:35], v22 offset:4096
    ds_read_b64_tr_b16 v[44:45], v26 offset:8192
    ds_read_b64_tr_b16 v[46:47], v26 offset:9216
    ds_read_b64_tr_b16 v[48:49], v27 offset:8192
    ds_read_b64_tr_b16 v[50:51], v27 offset:9216
    s_waitcnt lgkmcnt(6)
    v_mfma_f32_32x32x16_bf16 v[60:75], v[52:55], v[36:39], v[60:75]
    v_mfma_f32_32x32x16_bf16 v[76:91], v[56:59], v[36:39], v[76:91]
    v_mfma_f32_32x32x16_bf16 v[92:107], v[52:55], v[40:43], v[92:107]
    v_mfma_f32_32x32x16_bf16 v[108:123], v[56:59], v[40:43], v[108:123]
    ds_read_b128 v[36:39], v23 offset:0
    ds_read_b128 v[40:43], v23 offset:4096
    ds_read_b64_tr_b16 v[52:53], v26 offset:12288
    ds_read_b64_tr_b16 v[54:55], v26 offset:13312
    ds_read_b64_tr_b16 v[56:57], v27 offset:12288
    ds_read_b64_tr_b16 v[58:59], v27 offset:13312
    s_waitcnt lgkmcnt(6)
    v_mfma_f32_32x32x16_bf16 v[60:75], v[44:47], v[28:31], v[60:75]
    v_mfma_f32_32x32x16_bf16 v[76:91], v[48:51], v[28:31], v[76:91]
    v_mfma_f32_32x32x16_bf16 v[92:107], v[44:47], v[32:35], v[92:107]
    v_mfma_f32_32x32x16_bf16 v[108:123], v[48:51], v[32:35], v[108:123]
    s_waitcnt lgkmcnt(0)
    v_mfma_f32_32x32x16_bf16 v[60:75], v[52:55], v[36:39], v[60:75]
    v_mfma_f32_32x32x16_bf16 v[76:91], v[56:59], v[36:39], v[76:91]
    v_mfma_f32_32x32x16_bf16 v[92:107], v[52:55], v[40:43], v[92:107]
    v_mfma_f32_32x32x16_bf16 v[108:123], v[56:59], v[40:43], v[108:123]
    s_sub_u32 s18, s18, 1
    s_cmp_eq_u32 s18, 0
    s_cbranch_scc1 k1_kernel_N_done
    s_branch k1_kernel_N_loop
k1_kernel_N_done:
    s_nop 15
    s_barrier
    v_and_b32 v3, 31, v1
    v_lshrrev_b32 v4, 1, v2
    v_mul_u32_u24 v4, 64, v4
    v_add_u32 v3, v3, v4
    v_mul_u32_u24 v3, 272, v3
    v_and_b32 v4, 1, v2
    v_lshl_add_u32 v3, v4, 7, v3
    v_lshrrev_b32 v4, 5, v1
    v_lshl_add_u32 v3, v4, 3, v3
    v_max_f32 v60, s24, v60
    v_max_f32 v61, s24, v61
    v_max_f32 v62, s24, v62
    v_max_f32 v63, s24, v63
    v_cvt_pk_bf16_f32 v60, v60, v61
    v_cvt_pk_bf16_f32 v61, v62, v63
    ds_write_b64 v3, v[60:61] offset:0
    v_max_f32 v64, s24, v64
    v_max_f32 v65, s24, v65
    v_max_f32 v66, s24, v66
    v_max_f32 v67, s24, v67
    v_cvt_pk_bf16_f32 v64, v64, v65
    v_cvt_pk_bf16_f32 v65, v66, v67
    ds_write_b64 v3, v[64:65] offset:16
    v_max_f32 v68, s24, v68
    v_max_f32 v69, s24, v69
    v_max_f32 v70, s24, v70
    v_max_f32 v71, s24, v71
    v_cvt_pk_bf16_f32 v68, v68, v69
    v_cvt_pk_bf16_f32 v69, v70, v71
    ds_write_b64 v3, v[68:69] offset:32
    v_max_f32 v72, s24, v72
    v_max_f32 v73, s24, v73
    v_max_f32 v74, s24, v74
    v_max_f32 v75, s24, v75
    v_cvt_pk_bf16_f32 v72, v72, v73
    v_cvt_pk_bf16_f32 v73, v74, v75
    ds_write_b64 v3, v[72:73] offset:48
    v_max_f32 v76, s24, v76
    v_max_f32 v77, s24, v77
    v_max_f32 v78, s24, v78
    v_max_f32 v79, s24, v79
    v_cvt_pk_bf16_f32 v76, v76, v77
    v_cvt_pk_bf16_f32 v77, v78, v79
    ds_write_b64 v3, v[76:77] offset:64
    v_max_f32 v80, s24, v80
    v_max_f32 v81, s24, v81
    v_max_f32 v82, s24, v82
    v_max_f32 v83, s24, v83
    v_cvt_pk_bf16_f32 v80, v80, v81
    v_cvt_pk_bf16_f32 v81, v82, v83
    ds_write_b64 v3, v[80:81] offset:80
    v_max_f32 v84, s24, v84
    v_max_f32 v85, s24, v85
    v_max_f32 v86, s24, v86
    v_max_f32 v87, s24, v87
    v_cvt_pk_bf16_f32 v84, v84, v85
    v_cvt_pk_bf16_f32 v85, v86, v87
    ds_write_b64 v3, v[84:85] offset:96
    v_max_f32 v88, s24, v88
    v_max_f32 v89, s24, v89
    v_max_f32 v90, s24, v90
    v_max_f32 v91, s24, v91
    v_cvt_pk_bf16_f32 v88, v88, v89
    v_cvt_pk_bf16_f32 v89, v90, v91
    ds_write_b64 v3, v[88:89] offset:112
    v_max_f32 v92, s24, v92
    v_max_f32 v93, s24, v93
    v_max_f32 v94, s24, v94
    v_max_f32 v95, s24, v95
    v_cvt_pk_bf16_f32 v92, v92, v93
    v_cvt_pk_bf16_f32 v93, v94, v95
    ds_write_b64 v3, v[92:93] offset:8704
    v_max_f32 v96, s24, v96
    v_max_f32 v97, s24, v97
    v_max_f32 v98, s24, v98
    v_max_f32 v99, s24, v99
    v_cvt_pk_bf16_f32 v96, v96, v97
    v_cvt_pk_bf16_f32 v97, v98, v99
    ds_write_b64 v3, v[96:97] offset:8720
    v_max_f32 v100, s24, v100
    v_max_f32 v101, s24, v101
    v_max_f32 v102, s24, v102
    v_max_f32 v103, s24, v103
    v_cvt_pk_bf16_f32 v100, v100, v101
    v_cvt_pk_bf16_f32 v101, v102, v103
    ds_write_b64 v3, v[100:101] offset:8736
    v_max_f32 v104, s24, v104
    v_max_f32 v105, s24, v105
    v_max_f32 v106, s24, v106
    v_max_f32 v107, s24, v107
    v_cvt_pk_bf16_f32 v104, v104, v105
    v_cvt_pk_bf16_f32 v105, v106, v107
    ds_write_b64 v3, v[104:105] offset:8752
    v_max_f32 v108, s24, v108
    v_max_f32 v109, s24, v109
    v_max_f32 v110, s24, v110
    v_max_f32 v111, s24, v111
    v_cvt_pk_bf16_f32 v108, v108, v109
    v_cvt_pk_bf16_f32 v109, v110, v111
    ds_write_b64 v3, v[108:109] offset:8768
    v_max_f32 v112, s24, v112
    v_max_f32 v113, s24, v113
    v_max_f32 v114, s24, v114
    v_max_f32 v115, s24, v115
    v_cvt_pk_bf16_f32 v112, v112, v113
    v_cvt_pk_bf16_f32 v113, v114, v115
    ds_write_b64 v3, v[112:113] offset:8784
    v_max_f32 v116, s24, v116
    v_max_f32 v117, s24, v117
    v_max_f32 v118, s24, v118
    v_max_f32 v119, s24, v119
    v_cvt_pk_bf16_f32 v116, v116, v117
    v_cvt_pk_bf16_f32 v117, v118, v119
    ds_write_b64 v3, v[116:117] offset:8800
    v_max_f32 v120, s24, v120
    v_max_f32 v121, s24, v121
    v_max_f32 v122, s24, v122
    v_max_f32 v123, s24, v123
    v_cvt_pk_bf16_f32 v120, v120, v121
    v_cvt_pk_bf16_f32 v121, v122, v123
    ds_write_b64 v3, v[120:121] offset:8816
    s_waitcnt lgkmcnt(0)
    s_barrier
    v_lshrrev_b32 v3, 4, v1
    v_mul_u32_u24 v4, 32, v2
    v_add_u32 v3, v3, v4
    v_and_b32 v4, 15, v1
    v_mul_u32_u24 v5, 272, v3
    v_lshl_add_u32 v5, v4, 4, v5
    v_mul_lo_u32 v3, v3, s21
    v_lshl_add_u32 v3, v4, 4, v3
    s_mul_i32 s26, s21, 4
    s_mov_b32 s25, s28
    ds_read_b128 v[60:63], v5 offset:0
    ds_read_b128 v[64:67], v5 offset:1088
    ds_read_b128 v[68:71], v5 offset:2176
    ds_read_b128 v[72:75], v5 offset:3264
    ds_read_b128 v[76:79], v5 offset:4352
    ds_read_b128 v[80:83], v5 offset:5440
    ds_read_b128 v[84:87], v5 offset:6528
    ds_read_b128 v[88:91], v5 offset:7616
    s_waitcnt lgkmcnt(7)
    buffer_store_dwordx4 v[60:63], v3, s[12:15], s25 offen
    s_add_u32 s25, s25, s26
    s_waitcnt lgkmcnt(6)
    buffer_store_dwordx4 v[64:67], v3, s[12:15], s25 offen
    s_add_u32 s25, s25, s26
    s_waitcnt lgkmcnt(5)
    buffer_store_dwordx4 v[68:71], v3, s[12:15], s25 offen
    s_add_u32 s25, s25, s26
    s_waitcnt lgkmcnt(4)
    buffer_store_dwordx4 v[72:75], v3, s[12:15], s25 offen
    s_add_u32 s25, s25, s26
    s_waitcnt lgkmcnt(3)
    buffer_store_dwordx4 v[76:79], v3, s[12:15], s25 offen
    s_add_u32 s25, s25, s26
    s_waitcnt lgkmcnt(2)
    buffer_store_dwordx4 v[80:83], v3, s[12:15], s25 offen
    s_add_u32 s25, s25, s26
    s_waitcnt lgkmcnt(1)
    buffer_store_dwordx4 v[84:87], v3, s[12:15], s25 offen
    s_add_u32 s25, s25, s26
    s_waitcnt lgkmcnt(0)
    buffer_store_dwordx4 v[88:91], v3, s[12:15], s25 offen
    s_add_u32 s25, s25, s26
    s_waitcnt vmcnt(0)
    s_branch k1_kernel_end
k1_kernel_T:
    s_mov_b32 s29, s18
    s_add_u32 m0, s30, 0
    s_nop 0
    buffer_load_dwordx4 v8, s[4:7], s16 offen lds
    s_add_u32 m0, s30, 1024
    s_nop 0
    buffer_load_dwordx4 v9, s[4:7], s16 offen lds
    s_add_u32 m0, s30, 2048
    s_nop 0
    buffer_load_dwordx4 v10, s[4:7], s16 offen lds
    s_add_u32 m0, s30, 3072
    s_nop 0
    buffer_load_dwordx4 v11, s[4:7], s16 offen lds
    s_add_u32 m0, s31, 0
    s_nop 0
    buffer_load_dwordx4 v12, s[8:11], s17 offen lds
    s_add_u32 m0, s31, 1024
    s_nop 0
    buffer_load_dwordx4 v13, s[8:11], s17 offen lds
    s_add_u32 m0, s31, 2048
    s_nop 0
    buffer_load_dwordx4 v14, s[8:11], s17 offen lds
    s_add_u32 m0, s31, 3072
    s_nop 0
    buffer_load_dwordx4 v15, s[8:11], s17 offen lds
    s_add_u32 s16, s16, 128
    s_add_u32 s17, s17, s23
    s_sub_u32 s29, s29, 1
k1_kernel_T_loop:
    s_cmp_ge_u32 s18, 2
    s_cbranch_scc1 k1_kernel_T_w0
    s_waitcnt vmcnt(0)
k1_kernel_T_w0:
    s_waitcnt vmcnt(0)
    s_barrier
    ds_read_b128 v[28:31], v16 offset:0
    ds_read_b128 v[32:35], v16 offset:4096
    ds_read_b64_tr_b16 v[44:45], v24 offset:0
    ds_read_b64_tr_b16 v[46:47], v24 offset:1024
    ds_read_b64_tr_b16 v[48:49], v25 offset:0
    ds_read_b64_tr_b16 v[50:51], v25 offset:1024
    s_cmp_eq_u32 s29, 0
    s_cbranch_scc1 k1_kernel_T_nd0
    s_add_u32 m0, s30, 32768
    s_nop 0
    buffer_load_dwordx4 v8, s[4:7], s16 offen lds
    s_add_u32 m0, s30, 33792
    s_nop 0
    buffer_load_dwordx4 v9, s[4:7], s16 offen lds
    s_add_u32 m0, s30, 34816
    s_nop 0
    buffer_load_dwordx4 v10, s[4:7], s16 offen lds
    s_add_u32 m0, s30, 35840
    s_nop 0
    buffer_load_dwordx4 v11, s[4:7], s16 offen lds
    s_add_u32 m0, s31, 32768
    s_nop 0
    buffer_load_dwordx4 v12, s[8:11], s17 offen lds
    s_add_u32 m0, s31, 33792
    s_nop 0
    buffer_load_dwordx4 v13, s[8:11], s17 offen lds
    s_add_u32 m0, s31, 34816
    s_nop 0
    buffer_load_dwordx4 v14, s[8:11], s17 offen lds
    s_add_u32 m0, s31, 35840
    s_nop 0
    buffer_load_dwordx4 v15, s[8:11], s17 offen lds
    s_add_u32 s16, s16, 128
    s_add_u32 s17, s17, s23
    s_sub_u32 s29, s29, 1
k1_kernel_T_nd0:
    ds_read_b128 v[36:39], v17 offset:0
    ds_read_b128 v[40:43], v17 offset:4096
    ds_read_b64_tr_b16 v[52:53], v24 offset:4096
    ds_read_b64_tr_b16 v[54:55], v24 offset:5120
    ds_read_b64_tr_b16 v[56:57], v25 offset:4096
    ds_read_b64_tr_b16 v[58:59], v25 offset:5120
    s_waitcnt lgkmcnt(6)
    v_mfma_f32_32x32x16_bf16 v[60:75], v[28:31], v[44:47], v[60:75]
    v_mfma_f32_32x32x16_bf16 v[76:91], v[28:31], v[48:51], v[76:91]
    v_mfma_f32_32x32x16_bf16 v[92:107], v[32:35], v[44:47], v[92:107]
    v_mfma_f32_32x32x16_bf16 v[108:123], v[32:35], v[48:51], v[108:123]
    ds_read_b128 v[28:31], v18 offset:0
    ds_read_b128 v[32:35], v18 offset:4096
    ds_read_b64_tr_b16 v[44:45], v24 offset:8192
    ds_read_b64_tr_b16 v[46:47], v24 offset:9216
    ds_read_b64_tr_b16 v[48:49], v25 offset:8192
    ds_read_b64_tr_b16 v[50:51], v25 offset:9216
    s_waitcnt lgkmcnt(6)
    v_mfma_f32_32x32x16_bf16 v[60:75], v[36:39], v[52:55], v[60:75]
    v_mfma_f32_32x32x16_bf16 v[76:91], v[36:39], v[56:59], v[76:91]
    v_mfma_f32_32x32x16_bf16 v[92:107], v[40:43], v[52:55], v[92:107]
    v_mfma_f32_32x32x16_bf16 v[108:123], v[40:43], v[56:59], v[108:123]
    ds_read_b128 v[36:39], v19 offset:0
    ds_read_b128 v[40:43], v19 offset:4096
    ds_read_b64_tr_b16 v[52:53], v24 offset:12288
    ds_read_b64_tr_b16 v[54:55], v24 offset:13312
    ds_read_b64_tr_b16 v[56:57], v25 offset:12288
    ds_read_b64_tr_b16 v[58:59], v25 offset:13312
    s_waitcnt lgkmcnt(6)
    v_mfma_f32_32x32x16_bf16 v[60:75], v[28:31], v[44:47], v[60:75]
    v_mfma_f32_32x32x16_bf16 v[76:91], v[28:31], v[48:51], v[76:91]
    v_mfma_f32_32x32x16_bf16 v[92:107], v[32:35], v[44:47], v[92:107]
    v_mfma_f32_32x32x16_bf16 v[108:123], v[32:35], v[48:51], v[108:123]
    s_waitcnt lgkmcnt(0)
    v_mfma_f32_32x32x16_bf16 v[60:75], v[36:39], v[52:55], v[60:75]
    v_mfma_f32_32x32x16_bf16 v[76:91], v[36:39], v[56:59], v[76:91]
    v_mfma_f32_32x32x16_bf16 v[92:107], v[40:43], v[52:55], v[92:107]
    v_mfma_f32_32x32x16_bf16 v[108:123], v[40:43], v[56:59], v[108:123]
    s_sub_u32 s18, s18, 1
    s_cmp_eq_u32 s18, 0
    s_cbranch_scc1 k1_kernel_T_done
    s_cmp_ge_u32 s18, 2
    s_cbranch_scc1 k1_kernel_T_w1
    s_waitcnt vmcnt(0)
k1_kernel_T_w1:
    s_waitcnt vmcnt(0)
    s_barrier
    ds_read_b128 v[28:31], v20 offset:0
    ds_read_b128 v[32:35], v20 offset:4096
    ds_read_b64_tr_b16 v[44:45], v26 offset:0
    ds_read_b64_tr_b16 v[46:47], v26 offset:1024
    ds_read_b64_tr_b16 v[48:49], v27 offset:0
    ds_read_b64_tr_b16 v[50:51], v27 offset:1024
    s_cmp_eq_u32 s29, 0
    s_cbranch_scc1 k1_kernel_T_nd1
    s_add_u32 m0, s30, 0
    s_nop 0
    buffer_load_dwordx4 v8, s[4:7], s16 offen lds
    s_add_u32 m0, s30, 1024
    s_nop 0
    buffer_load_dwordx4 v9, s[4:7], s16 offen lds
    s_add_u32 m0, s30, 2048
    s_nop 0
    buffer_load_dwordx4 v10, s[4:7], s16 offen lds
    s_add_u32 m0, s30, 3072
    s_nop 0
    buffer_load_dwordx4 v11, s[4:7], s16 offen lds
    s_add_u32 m0, s31, 0
    s_nop 0
    buffer_load_dwordx4 v12, s[8:11], s17 offen lds
    s_add_u32 m0, s31, 1024
    s_nop 0
    buffer_load_dwordx4 v13, s[8:11], s17 offen lds
    s_add_u32 m0, s31, 2048
    s_nop 0
    buffer_load_dwordx4 v14, s[8:11], s17 offen lds
    s_add_u32 m0, s31, 3072
    s_nop 0
    buffer_load_dwordx4 v15, s[8:11], s17 offen lds
    s_add_u32 s16, s16, 128
    s_add_u32 s17, s17, s23
    s_sub_u32 s29, s29, 1
k1_kernel_T_nd1:
    ds_read_b128 v[36:39], v21 offset:0
    ds_read_b128 v[40:43], v21 offset:4096
    ds_read_b64_tr_b16 v[52:53], v26 offset:4096
    ds_read_b64_tr_b16 v[54:55], v26 offset:5120
    ds_read_b64_tr_b16 v[56:57], v27 offset:4096
    ds_read_b64_tr_b16 v[58:59], v27 offset:5120
    s_waitcnt lgkmcnt(6)
    v_mfma_f32_32x32x16_bf16 v[60:75], v[28:31], v[44:47], v[60:75]
    v_mfma_f32_32x32x16_bf16 v[76:91], v[28:31], v[48:51], v[76:91]
    v_mfma_f32_32x32x16_bf16 v[92:107], v[32:35], v[44:47], v[92:107]
    v_mfma_f32_32x32x16_bf16 v[108:123], v[32:35], v[48:51], v[108:123]
    ds_read_b128 v[28:31], v22 offset:0
    ds_read_b128 v[32:35], v22 offset:4096
    ds_read_b64_tr_b16 v[44:45], v26 offset:8192
    ds_read_b64_tr_b16 v[46:47], v26 offset:9216
    ds_read_b64_tr_b16 v[48:49], v27 offset:8192
    ds_read_b64_tr_b16 v[50:51], v27 offset:9216
    s_waitcnt lgkmcnt(6)
    v_mfma_f32_32x32x16_bf16 v[60:75], v[36:39], v[52:55], v[60:75]
    v_mfma_f32_32x32x16_bf16 v[76:91], v[36:39], v[56:59], v[76:91]
    v_mfma_f32_32x32x16_bf16 v[92:107], v[40:43], v[52:55], v[92:107]
    v_mfma_f32_32x32x16_bf16 v[108:123], v[40:43], v[56:59], v[108:123]
    ds_read_b128 v[36:39], v23 offset:0
    ds_read_b128 v[40:43], v23 offset:4096
    ds_read_b64_tr_b16 v[52:53], v26 offset:12288
    ds_read_b64_tr_b16 v[54:55], v26 offset:13312
    ds_read_b64_tr_b16 v[56:57], v27 offset:12288
    ds_read_b64_tr_b16 v[58:59], v27 offset:13312
    s_waitcnt lgkmcnt(6)
    v_mfma_f32_32x32x16_bf16 v[60:75], v[28:31], v[44:47], v[60:75]
    v_mfma_f32_32x32x16_bf16 v[76:91], v[28:31], v[48:51], v[76:91]
    v_mfma_f32_32x32x16_bf16 v[92:107], v[32:35], v[44:47], v[92:107]
    v_mfma_f32_32x32x16_bf16 v[108:123], v[32:35], v[48:51], v[108:123]
    s_waitcnt lgkmcnt(0)
    v_mfma_f32_32x32x16_bf16 v[60:75], v[36:39], v[52:55], v[60:75]
    v_mfma_f32_32x32x16_bf16 v[76:91], v[36:39], v[56:59], v[76:91]
    v_mfma_f32_32x32x16_bf16 v[92:107], v[40:43], v[52:55], v[92:107]
    v_mfma_f32_32x32x16_bf16 v[108:123], v[40:43], v[56:59], v[108:123]
    s_sub_u32 s18, s18, 1
    s_cmp_eq_u32 s18, 0
    s_cbranch_scc1 k1_kernel_T_done
    s_branch k1_kernel_T_loop
k1_kernel_T_done:
    s_nop 15
    s_barrier
    v_and_b32 v3, 31, v1
    v_and_b32 v4, 1, v2
    v_lshl_add_u32 v3, v4, 6, v3
    v_mul_u32_u24 v3, 272, v3
    v_lshrrev_b32 v4, 1, v2
    v_mul_u32_u24 v4, 128, v4
    v_add_u32 v3, v3, v4
    v_lshrrev_b32 v4, 5, v1
    v_lshl_add_u32 v3, v4, 4, v3
    v_cvt_pk_bf16_f32 v60, v60, v61
    v_cvt_pk_bf16_f32 v61, v62, v63
    ds_write_b64 v3, v[60:61] offset:0
    v_cvt_pk_bf16_f32 v64, v64, v65
    v_cvt_pk_bf16_f32 v65, v66, v67
    ds_write_b64 v3, v[64:65] offset:8
    v_cvt_pk_bf16_f32 v68, v68, v69
    v_cvt_pk_bf16_f32 v69, v70, v71
    ds_write_b64 v3, v[68:69] offset:32
    v_cvt_pk_bf16_f32 v72, v72, v73
    v_cvt_pk_bf16_f32 v73, v74, v75
    ds_write_b64 v3, v[72:73] offset:40
    v_cvt_pk_bf16_f32 v76, v76, v77
    v_cvt_pk_bf16_f32 v77, v78, v79
    ds_write_b64 v3, v[76:77] offset:8704
    v_cvt_pk_bf16_f32 v80, v80, v81
    v_cvt_pk_bf16_f32 v81, v82, v83
    ds_write_b64 v3, v[80:81] offset:8712
    v_cvt_pk_bf16_f32 v84, v84, v85
    v_cvt_pk_bf16_f32 v85, v86, v87
    ds_write_b64 v3, v[84:85] offset:8736
    v_cvt_pk_bf16_f32 v88, v88, v89
    v_cvt_pk_bf16_f32 v89, v90, v91
    ds_write_b64 v3, v[88:89] offset:8744
    v_cvt_pk_bf16_f32 v92, v92, v93
    v_cvt_pk_bf16_f32 v93, v94, v95
    ds_write_b64 v3, v[92:93] offset:64
    v_cvt_pk_bf16_f32 v96, v96, v97
    v_cvt_pk_bf16_f32 v97, v98, v99
    ds_write_b64 v3, v[96:97] offset:72
    v_cvt_pk_bf16_f32 v100, v100, v101
    v_cvt_pk_bf16_f32 v101, v102, v103
    ds_write_b64 v3, v[100:101] offset:96
    v_cvt_pk_bf16_f32 v104, v104, v105
    v_cvt_pk_bf16_f32 v105, v106, v107
    ds_write_b64 v3, v[104:105] offset:104
    v_cvt_pk_bf16_f32 v108, v108, v109
    v_cvt_pk_bf16_f32 v109, v110, v111
    ds_write_b64 v3, v[108:109] offset:8768
    v_cvt_pk_bf16_f32 v112, v112, v113
    v_cvt_pk_bf16_f32 v113, v114, v115
    ds_write_b64 v3, v[112:113] offset:8776
    v_cvt_pk_bf16_f32 v116, v116, v117
    v_cvt_pk_bf16_f32 v117, v118, v119
    ds_write_b64 v3, v[116:117] offset:8800
    v_cvt_pk_bf16_f32 v120, v120, v121
    v_cvt_pk_bf16_f32 v121, v122, v123
    ds_write_b64 v3, v[120:121] offset:8808
    s_waitcnt lgkmcnt(0)
    s_barrier
    v_lshrrev_b32 v3, 4, v1
    v_mul_u32_u24 v4, 32, v2
    v_add_u32 v3, v3, v4
    v_and_b32 v4, 15, v1
    v_mul_u32_u24 v5, 272, v3
    v_lshl_add_u32 v5, v4, 4, v5
    v_mul_lo_u32 v3, v3, s21
    v_lshl_add_u32 v3, v4, 4, v3
    s_mul_i32 s26, s21, 4
    s_mov_b32 s25, s28
    ds_read_b128 v[60:63], v5 offset:0
    ds_read_b128 v[64:67], v5 offset:1088
    ds_read_b128 v[68:71], v5 offset:2176
    ds_read_b128 v[72:75], v5 offset:3264
    ds_read_b128 v[76:79], v5 offset:4352
    ds_read_b128 v[80:83], v5 offset:5440
    ds_read_b128 v[84:87], v5 offset:6528
    ds_read_b128 v[88:91], v5 offset:7616
    s_waitcnt lgkmcnt(7)
    buffer_store_dwordx4 v[60:63], v3, s[12:15], s25 offen
    s_add_u32 s25, s25, s26
    s_waitcnt lgkmcnt(6)
    buffer_store_dwordx4 v[64:67], v3, s[12:15], s25 offen
    s_add_u32 s25, s25, s26
    s_waitcnt lgkmcnt(5)
    buffer_store_dwordx4 v[68:71], v3, s[12:15], s25 offen
    s_add_u32 s25, s25, s26
    s_waitcnt lgkmcnt(4)
    buffer_store_dwordx4 v[72:75], v3, s[12:15], s25 offen
    s_add_u32 s25, s25, s26
    s_waitcnt lgkmcnt(3)
    buffer_store_dwordx4 v[76:79], v3, s[12:15], s25 offen
    s_add_u32 s25, s25, s26
    s_waitcnt lgkmcnt(2)
    buffer_store_dwordx4 v[80:83], v3, s[12:15], s25 offen
    s_add_u32 s25, s25, s26
    s_waitcnt lgkmcnt(1)
    buffer_store_dwordx4 v[84:87], v3, s[12:15], s25 offen
    s_add_u32 s25, s25, s26
    s_waitcnt lgkmcnt(0)
    buffer_store_dwordx4 v[88:91], v3, s[12:15], s25 offen
    s_add_u32 s25, s25, s26
    s_waitcnt vmcnt(0)
k1_kernel_end:
    s_endpgm
.section .rodata,"a"
.p2align 6
.amdhsa_kernel k1_kernel
  .amdhsa_next_free_vgpr 124
  .amdhsa_next_free_sgpr 102
  .amdhsa_accum_offset 124
  .amdhsa_group_segment_fixed_size 0
  .amdhsa_kernarg_size 104
  .amdhsa_user_sgpr_count 2
  .amdhsa_user_sgpr_kernarg_segment_ptr 1
  .amdhsa_system_sgpr_workgroup_id_x 1
.end_amdhsa_kernel
.text
.globl k2_kernel
.p2align 8
.type k2_kernel,@function
k2_kernel:
    s_cmp_ge_u32 s2, 512
    s_cbranch_scc1 k2_kernel_end
    s_load_dwordx2 s[32:33], s[0:1], 96
    s_lshr_b32 s34, s2, 5
    s_and_b32 s35, s2, 31
    s_sub_u32 s36, 15, s34
    s_sub_u32 s37, s34, 8
    s_cmp_lt_u32 s34, 8
    s_cselect_b32 s36, s36, s37
    s_lshl_b32 s18, s36, 1
    s_add_u32 s18, s18, 2
    s_waitcnt lgkmcnt(0)
    s_add_u32 s4, s32, 16777216
    s_addc_u32 s5, s33, 0
    s_mov_b32 s6, 16777216
    s_mov_b32 s7, 0x00020000
    s_add_u32 s8, s32, 33554432
    s_addc_u32 s9, s33, 0
    s_mov_b32 s10, 16777216
    s_mov_b32 s11, 0x00020000
    s_mov_b32 s12, s32
    s_mov_b32 s13, s33
    s_mov_b32 s14, 16777216
    s_mov_b32 s15, 0x00020000
    s_add_u32 s40, s32, 75497472
    s_addc_u32 s41, s33, 0
    s_mov_b32 s42, 16777216
    s_mov_b32 s43, 0x00020000
    v_and_b32 v1, 63, v0
    v_lshrrev_b32 v2, 6, v0
    s_nop 0
    v_readfirstlane_b32 s22, v2
    v_lshrrev_b32 v3, 4, v1
    v_lshl_add_u32 v3, v2, 4, v3
    v_and_b32 v4, 15, v1
    v_add_u32 v5, 0, v3
    v_and_b32 v6, 15, v5
    v_xor_b32 v6, v6, v4
    v_lshlrev_b32 v5, 13, v5
    v_lshl_add_u32 v20, v6, 4, v5
    v_add_u32 v5, 4, v3
    v_and_b32 v6, 15, v5
    v_xor_b32 v6, v6, v4
    v_lshlrev_b32 v5, 13, v5
    v_lshl_add_u32 v21, v6, 4, v5
    v_add_u32 v5, 8, v3
    v_and_b32 v6, 15, v5
    v_xor_b32 v6, v6, v4
    v_lshlrev_b32 v5, 13, v5
    v_lshl_add_u32 v22, v6, 4, v5
    v_add_u32 v5, 12, v3
    v_and_b32 v6, 15, v5
    v_xor_b32 v6, v6, v4
    v_lshlrev_b32 v5, 13, v5
    v_lshl_add_u32 v23, v6, 4, v5
    v_lshrrev_b32 v3, 3, v1
    v_lshl_add_u32 v3, v2, 5, v3
    v_and_b32 v4, 7, v1
    v_add_u32 v5, 0, v3
    v_lshrrev_b32 v6, 1, v5
    v_and_b32 v6, 7, v6
    v_xor_b32 v6, v6, v4
    v_lshlrev_b32 v5, 12, v5
    v_lshl_add_u32 v24, v6, 4, v5
    v_add_u32 v5, 8, v3
    v_lshrrev_b32 v6, 1, v5
    v_and_b32 v6, 7, v6
    v_xor_b32 v6, v6, v4
    v_lshlrev_b32 v5, 12, v5
    v_lshl_add_u32 v25, v6, 4, v5
    v_add_u32 v5, 16, v3
    v_lshrrev_b32 v6, 1, v5
    v_and_b32 v6, 7, v6
    v_xor_b32 v6, v6, v4
    v_lshlrev_b32 v5, 12, v5
    v_lshl_add_u32 v26, v6, 4, v5
    v_add_u32 v5, 24, v3
    v_lshrrev_b32 v6, 1, v5
    v_and_b32 v6, 7, v6
    v_xor_b32 v6, v6, v4
    v_lshlrev_b32 v5, 12, v5
    v_lshl_add_u32 v27, v6, 4, v5
    v_and_b32 v3, 31, v1
    v_lshrrev_b32 v5, 5, v1
    v_and_b32 v6, 15, v3
    v_lshlrev_b32 v7, 8, v3
    v_add_u32 v194, 0, v5
    v_xor_b32 v194, v194, v6
    v_lshl_add_u32 v8, v194, 4, v7
    v_add_u32 v194, 2, v5
    v_xor_b32 v194, v194, v6
    v_lshl_add_u32 v9, v194, 4, v7
    v_add_u32 v194, 4, v5
    v_xor_b32 v194, v194, v6
    v_lshl_add_u32 v10, v194, 4, v7
    v_add_u32 v194, 6, v5
    v_xor_b32 v194, v194, v6
    v_lshl_add_u32 v11, v194, 4, v7
    v_add_u32 v194, 8, v5
    v_xor_b32 v194, v194, v6
    v_lshl_add_u32 v12, v194, 4, v7
    v_add_u32 v194, 10, v5
    v_xor_b32 v194, v194, v6
    v_lshl_add_u32 v13, v194, 4, v7
    v_add_u32 v194, 12, v5
    v_xor_b32 v194, v194, v6
    v_lshl_add_u32 v14, v194, 4, v7
    v_add_u32 v194, 14, v5
    v_xor_b32 v194, v194, v6
    v_lshl_add_u32 v15, v194, 4, v7
    v_lshrrev_b32 v6, 1, v3
    v_and_b32 v6, 7, v6
    v_lshlrev_b32 v7, 7, v3
    v_add_u32 v7, 16384, v7
    v_add_u32 v194, 0, v5
    v_xor_b32 v194, v194, v6
    v_lshl_add_u32 v16, v194, 4, v7
    v_add_u32 v194, 2, v5
    v_xor_b32 v194, v194, v6
    v_lshl_add_u32 v17, v194, 4, v7
    v_add_u32 v194, 4, v5
    v_xor_b32 v194, v194, v6
    v_lshl_add_u32 v18, v194, 4, v7
    v_add_u32 v194, 6, v5
    v_xor_b32 v194, v194, v6
    v_lshl_add_u32 v19, v194, 4, v7
    s_lshl_b32 s25, s36, 7
    v_lshl_add_u32 v3, v2, 5, v3
    v_add_u32 v3, s25, v3
    v_mov_b32 v198, v3
    v_lshlrev_b32 v4, 13, v3
    v_lshl_add_u32 v4, v5, 4, v4
    s_lshl_b32 s25, s35, 8
    buffer_load_dwordx4 v[32:35], v4, s[12:15], s25 offen offset:0
    buffer_load_dwordx4 v[36:39], v4, s[12:15], s25 offen offset:32
    buffer_load_dwordx4 v[40:43], v4, s[12:15], s25 offen offset:64
    buffer_load_dwordx4 v[44:47], v4, s[12:15], s25 offen offset:96
    buffer_load_dwordx4 v[48:51], v4, s[12:15], s25 offen offset:128
    buffer_load_dwordx4 v[52:55], v4, s[12:15], s25 offen offset:160
    buffer_load_dwordx4 v[56:59], v4, s[12:15], s25 offen offset:192
    buffer_load_dwordx4 v[60:63], v4, s[12:15], s25 offen offset:224
    v_lshlrev_b32 v6, 2, v5
    v_sub_u32 v198, v198, v6
    v_mov_b32 v96, 0
    v_mov_b32 v97, 0
    v_mov_b32 v98, 0
    v_mov_b32 v99, 0
    v_mov_b32 v100, 0
    v_mov_b32 v101, 0
    v_mov_b32 v102, 0
    v_mov_b32 v103, 0
    v_mov_b32 v104, 0
    v_mov_b32 v105, 0
    v_mov_b32 v106, 0
    v_mov_b32 v107, 0
    v_mov_b32 v108, 0
    v_mov_b32 v109, 0
    v_mov_b32 v110, 0
    v_mov_b32 v111, 0
    v_mov_b32 v112, 0
    v_mov_b32 v113, 0
    v_mov_b32 v114, 0
    v_mov_b32 v115, 0
    v_mov_b32 v116, 0
    v_mov_b32 v117, 0
    v_mov_b32 v118, 0
    v_mov_b32 v119, 0
    v_mov_b32 v120, 0
    v_mov_b32 v121, 0
    v_mov_b32 v122, 0
    v_mov_b32 v123, 0
    v_mov_b32 v124, 0
    v_mov_b32 v125, 0
    v_mov_b32 v126, 0
    v_mov_b32 v127, 0
    v_mov_b32 v128, 0
    v_mov_b32 v129, 0
    v_mov_b32 v130, 0
    v_mov_b32 v131, 0
    v_mov_b32 v132, 0
    v_mov_b32 v133, 0
    v_mov_b32 v134, 0
    v_mov_b32 v135, 0
    v_mov_b32 v136, 0
    v_mov_b32 v137, 0
    v_mov_b32 v138, 0
    v_mov_b32 v139, 0
    v_mov_b32 v140, 0
    v_mov_b32 v141, 0
    v_mov_b32 v142, 0
    v_mov_b32 v143, 0
    v_mov_b32 v144, 0
    v_mov_b32 v145, 0
    v_mov_b32 v146, 0
    v_mov_b32 v147, 0
    v_mov_b32 v148, 0
    v_mov_b32 v149, 0
    v_mov_b32 v150, 0
    v_mov_b32 v151, 0
    v_mov_b32 v152, 0
    v_mov_b32 v153, 0
    v_mov_b32 v154, 0
    v_mov_b32 v155, 0
    v_mov_b32 v156, 0
    v_mov_b32 v157, 0
    v_mov_b32 v158, 0
    v_mov_b32 v159, 0
    v_mov_b32 v192, 0xff800000
    v_mov_b32 v193, 0
    s_lshl_b32 s16, s35, 8
    s_lshl_b32 s17, s35, 19
    s_mov_b32 s30, 0
    s_lshl_b32 s31, s22, 12
    s_mov_b32 s19, 0
    s_mov_b32 s21, 0x3e0293ee
    s_add_u32 s25, s30, s31
    s_add_u32 m0, s25, 0
    s_nop 0
    buffer_load_dwordx4 v20, s[4:7], s16 offen lds
    s_add_u32 m0, s25, 1024
    s_nop 0
    buffer_load_dwordx4 v21, s[4:7], s16 offen lds
    s_add_u32 m0, s25, 2048
    s_nop 0
    buffer_load_dwordx4 v22, s[4:7], s16 offen lds
    s_add_u32 m0, s25, 3072
    s_nop 0
    buffer_load_dwordx4 v23, s[4:7], s16 offen lds
    s_add_u32 m0, s25, 16384
    s_nop 0
    buffer_load_dwordx4 v24, s[8:11], s17 offen lds
    s_add_u32 m0, s25, 17408
    s_nop 0
    buffer_load_dwordx4 v25, s[8:11], s17 offen lds
    s_add_u32 m0, s25, 18432
    s_nop 0
    buffer_load_dwordx4 v26, s[8:11], s17 offen lds
    s_add_u32 m0, s25, 19456
    s_nop 0
    buffer_load_dwordx4 v27, s[8:11], s17 offen lds
    s_add_u32 s16, s16, 524288
    s_add_u32 s17, s17, 128
    s_xor_b32 s30, s30, 32768
    s_sub_u32 s20, s18, 2
k2_kernel_loop:
    s_cmp_ge_u32 s19, s20
    s_cbranch_scc1 k2_kernel_mloop
    s_waitcnt vmcnt(0)
    s_barrier
    ds_read_b128 v[160:163], v8 offset:0
    ds_read_b128 v[164:167], v8 offset:8192
    ds_read_b128 v[168:171], v9 offset:0
    ds_read_b128 v[172:175], v9 offset:8192
    s_add_u32 s25, s19, 1
    s_cmp_ge_u32 s25, s18
    s_cbranch_scc1 k2_kernel_nodma_u
    s_add_u32 s25, s30, s31
    s_add_u32 m0, s25, 0
    s_nop 0
    buffer_load_dwordx4 v20, s[4:7], s16 offen lds
    s_add_u32 m0, s25, 1024
    s_nop 0
    buffer_load_dwordx4 v21, s[4:7], s16 offen lds
    s_add_u32 m0, s25, 2048
    s_nop 0
    buffer_load_dwordx4 v22, s[4:7], s16 offen lds
    s_add_u32 m0, s25, 3072
    s_nop 0
    buffer_load_dwordx4 v23, s[4:7], s16 offen lds
    s_add_u32 m0, s25, 16384
    s_nop 0
    buffer_load_dwordx4 v24, s[8:11], s17 offen lds
    s_add_u32 m0, s25, 17408
    s_nop 0
    buffer_load_dwordx4 v25, s[8:11], s17 offen lds
    s_add_u32 m0, s25, 18432
    s_nop 0
    buffer_load_dwordx4 v26, s[8:11], s17 offen lds
    s_add_u32 m0, s25, 19456
    s_nop 0
    buffer_load_dwordx4 v27, s[8:11], s17 offen lds
    s_add_u32 s16, s16, 524288
    s_add_u32 s17, s17, 128
    s_xor_b32 s30, s30, 32768
k2_kernel_nodma_u:
    s_waitcnt lgkmcnt(3)
    v_mfma_f32_32x32x16_bf16 v[64:79], v[160:163], v[32:35], 0
    ds_read_b128 v[160:163], v10 offset:0
    s_waitcnt lgkmcnt(3)
    v_mfma_f32_32x32x16_bf16 v[80:95], v[164:167], v[32:35], 0
    ds_read_b128 v[164:167], v10 offset:8192
    s_waitcnt lgkmcnt(3)
    v_mfma_f32_32x32x16_bf16 v[64:79], v[168:171], v[36:39], v[64:79]
    ds_read_b128 v[168:171], v11 offset:0
    s_waitcnt lgkmcnt(3)
    v_mfma_f32_32x32x16_bf16 v[80:95], v[172:175], v[36:39], v[80:95]
    ds_read_b128 v[172:175], v11 offset:8192
    s_waitcnt lgkmcnt(3)
    v_mfma_f32_32x32x16_bf16 v[64:79], v[160:163], v[40:43], v[64:79]
    ds_read_b128 v[160:163], v12 offset:0
    s_waitcnt lgkmcnt(3)
    v_mfma_f32_32x32x16_bf16 v[80:95], v[164:167], v[40:43], v[80:95]
    ds_read_b128 v[164:167], v12 offset:8192
    s_waitcnt lgkmcnt(3)
    v_mfma_f32_32x32x16_bf16 v[64:79], v[168:171], v[44:47], v[64:79]
    ds_read_b128 v[168:171], v13 offset:0
    s_waitcnt lgkmcnt(3)
    v_mfma_f32_32x32x16_bf16 v[80:95], v[172:175], v[44:47], v[80:95]
    ds_read_b128 v[172:175], v13 offset:8192
    s_waitcnt lgkmcnt(3)
    v_mfma_f32_32x32x16_bf16 v[64:79], v[160:163], v[48:51], v[64:79]
    ds_read_b128 v[160:163], v14 offset:0
    s_waitcnt lgkmcnt(3)
    v_mfma_f32_32x32x16_bf16 v[80:95], v[164:167], v[48:51], v[80:95]
    ds_read_b128 v[164:167], v14 offset:8192
    s_waitcnt lgkmcnt(3)
    v_mfma_f32_32x32x16_bf16 v[64:79], v[168:171], v[52:55], v[64:79]
    ds_read_b128 v[168:171], v15 offset:0
    s_waitcnt lgkmcnt(3)
    v_mfma_f32_32x32x16_bf16 v[80:95], v[172:175], v[52:55], v[80:95]
    ds_read_b128 v[172:175], v15 offset:8192
    s_waitcnt lgkmcnt(3)
    v_mfma_f32_32x32x16_bf16 v[64:79], v[160:163], v[56:59], v[64:79]
    s_waitcnt lgkmcnt(2)
    v_mfma_f32_32x32x16_bf16 v[80:95], v[164:167], v[56:59], v[80:95]
    s_waitcnt lgkmcnt(1)
    v_mfma_f32_32x32x16_bf16 v[64:79], v[168:171], v[60:63], v[64:79]
    s_waitcnt lgkmcnt(0)
    v_mfma_f32_32x32x16_bf16 v[80:95], v[172:175], v[60:63], v[80:95]
    ds_read_b128 v[160:163], v16 offset:0
    ds_read_b128 v[164:167], v16 offset:4096
    ds_read_b128 v[168:171], v16 offset:8192
    ds_read_b128 v[172:175], v16 offset:12288
    s_nop 7
    s_nop 7
    v_max3_f32 v194, v64, v65, v66
    v_max3_f32 v194, v194, v67, v68
    v_max3_f32 v194, v194, v69, v70
    v_max3_f32 v194, v194, v71, v72
    v_max3_f32 v194, v194, v73, v74
    v_max3_f32 v194, v194, v75, v76
    v_max3_f32 v194, v194, v77, v78
    v_max3_f32 v194, v194, v79, v80
    v_max3_f32 v194, v194, v81, v82
    v_max3_f32 v194, v194, v83, v84
    v_max3_f32 v194, v194, v85, v86
    v_max3_f32 v194, v194, v87, v88
    v_max3_f32 v194, v194, v89, v90
    v_max3_f32 v194, v194, v91, v92
    v_max3_f32 v194, v194, v93, v94
    v_max_f32 v194, v194, v95
    v_mov_b32 v195, v194
    s_nop 1
    v_permlane32_swap_b32 v194, v195
    s_nop 1
    v_max3_f32 v194, v194, v195, v192
    v_sub_f32 v196, v192, v194
    v_mul_f32 v196, s21, v196
    v_exp_f32 v196, v196
    v_mov_b32 v192, v194
    v_mul_f32 v197, s21, v194
    v_sub_f32 v197, 0, v197
    v_fma_f32 v64, v64, s21, v197
    v_fma_f32 v65, v65, s21, v197
    v_fma_f32 v66, v66, s21, v197
    v_fma_f32 v67, v67, s21, v197
    v_fma_f32 v68, v68, s21, v197
    v_fma_f32 v69, v69, s21, v197
    v_fma_f32 v70, v70, s21, v197
    v_fma_f32 v71, v71, s21, v197
    v_fma_f32 v72, v72, s21, v197
    v_fma_f32 v73, v73, s21, v197
    v_fma_f32 v74, v74, s21, v197
    v_fma_f32 v75, v75, s21, v197
    v_fma_f32 v76, v76, s21, v197
    v_fma_f32 v77, v77, s21, v197
    v_fma_f32 v78, v78, s21, v197
    v_fma_f32 v79, v79, s21, v197
    v_fma_f32 v80, v80, s21, v197
    v_fma_f32 v81, v81, s21, v197
    v_fma_f32 v82, v82, s21, v197
    v_fma_f32 v83, v83, s21, v197
    v_fma_f32 v84, v84, s21, v197
    v_fma_f32 v85, v85, s21, v197
    v_fma_f32 v86, v86, s21, v197
    v_fma_f32 v87, v87, s21, v197
    v_fma_f32 v88, v88, s21, v197
    v_fma_f32 v89, v89, s21, v197
    v_fma_f32 v90, v90, s21, v197
    v_fma_f32 v91, v91, s21, v197
    v_fma_f32 v92, v92, s21, v197
    v_fma_f32 v93, v93, s21, v197
    v_fma_f32 v94, v94, s21, v197
    v_fma_f32 v95, v95, s21, v197
    v_exp_f32 v64, v64
    v_exp_f32 v65, v65
    v_exp_f32 v66, v66
    v_exp_f32 v67, v67
    v_exp_f32 v68, v68
    v_exp_f32 v69, v69
    v_exp_f32 v70, v70
    v_exp_f32 v71, v71
    v_exp_f32 v72, v72
    v_exp_f32 v73, v73
    v_exp_f32 v74, v74
    v_exp_f32 v75, v75
    v_exp_f32 v76, v76
    v_exp_f32 v77, v77
    v_exp_f32 v78, v78
    v_exp_f32 v79, v79
    v_exp_f32 v80, v80
    v_exp_f32 v81, v81
    v_exp_f32 v82, v82
    v_exp_f32 v83, v83
    v_exp_f32 v84, v84
    v_exp_f32 v85, v85
    v_exp_f32 v86, v86
    v_exp_f32 v87, v87
    v_exp_f32 v88, v88
    v_exp_f32 v89, v89
    v_exp_f32 v90, v90
    v_exp_f32 v91, v91
    v_exp_f32 v92, v92
    v_exp_f32 v93, v93
    v_exp_f32 v94, v94
    v_exp_f32 v95, v95
    v_mul_f32 v193, v193, v196
    v_add_f32 v193, v193, v64
    v_add_f32 v193, v193, v65
    v_add_f32 v193, v193, v66
    v_add_f32 v193, v193, v67
    v_add_f32 v193, v193, v68
    v_add_f32 v193, v193, v69
    v_add_f32 v193, v193, v70
    v_add_f32 v193, v193, v71
    v_add_f32 v193, v193, v72
    v_add_f32 v193, v193, v73
    v_add_f32 v193, v193, v74
    v_add_f32 v193, v193, v75
    v_add_f32 v193, v193, v76
    v_add_f32 v193, v193, v77
    v_add_f32 v193, v193, v78
    v_add_f32 v193, v193, v79
    v_add_f32 v193, v193, v80
    v_add_f32 v193, v193, v81
    v_add_f32 v193, v193, v82
    v_add_f32 v193, v193, v83
    v_add_f32 v193, v193, v84
    v_add_f32 v193, v193, v85
    v_add_f32 v193, v193, v86
    v_add_f32 v193, v193, v87
    v_add_f32 v193, v193, v88
    v_add_f32 v193, v193, v89
    v_add_f32 v193, v193, v90
    v_add_f32 v193, v193, v91
    v_add_f32 v193, v193, v92
    v_add_f32 v193, v193, v93
    v_add_f32 v193, v193, v94
    v_add_f32 v193, v193, v95
    v_mul_f32 v96, v96, v196
    v_mul_f32 v97, v97, v196
    v_mul_f32 v98, v98, v196
    v_mul_f32 v99, v99, v196
    v_mul_f32 v100, v100, v196
    v_mul_f32 v101, v101, v196
    v_mul_f32 v102, v102, v196
    v_mul_f32 v103, v103, v196
    v_mul_f32 v104, v104, v196
    v_mul_f32 v105, v105, v196
    v_mul_f32 v106, v106, v196
    v_mul_f32 v107, v107, v196
    v_mul_f32 v108, v108, v196
    v_mul_f32 v109, v109, v196
    v_mul_f32 v110, v110, v196
    v_mul_f32 v111, v111, v196
    v_mul_f32 v112, v112, v196
    v_mul_f32 v113, v113, v196
    v_mul_f32 v114, v114, v196
    v_mul_f32 v115, v115, v196
    v_mul_f32 v116, v116, v196
    v_mul_f32 v117, v117, v196
    v_mul_f32 v118, v118, v196
    v_mul_f32 v119, v119, v196
    v_mul_f32 v120, v120, v196
    v_mul_f32 v121, v121, v196
    v_mul_f32 v122, v122, v196
    v_mul_f32 v123, v123, v196
    v_mul_f32 v124, v124, v196
    v_mul_f32 v125, v125, v196
    v_mul_f32 v126, v126, v196
    v_mul_f32 v127, v127, v196
    v_mul_f32 v128, v128, v196
    v_mul_f32 v129, v129, v196
    v_mul_f32 v130, v130, v196
    v_mul_f32 v131, v131, v196
    v_mul_f32 v132, v132, v196
    v_mul_f32 v133, v133, v196
    v_mul_f32 v134, v134, v196
    v_mul_f32 v135, v135, v196
    v_mul_f32 v136, v136, v196
    v_mul_f32 v137, v137, v196
    v_mul_f32 v138, v138, v196
    v_mul_f32 v139, v139, v196
    v_mul_f32 v140, v140, v196
    v_mul_f32 v141, v141, v196
    v_mul_f32 v142, v142, v196
    v_mul_f32 v143, v143, v196
    v_mul_f32 v144, v144, v196
    v_mul_f32 v145, v145, v196
    v_mul_f32 v146, v146, v196
    v_mul_f32 v147, v147, v196
    v_mul_f32 v148, v148, v196
    v_mul_f32 v149, v149, v196
    v_mul_f32 v150, v150, v196
    v_mul_f32 v151, v151, v196
    v_mul_f32 v152, v152, v196
    v_mul_f32 v153, v153, v196
    v_mul_f32 v154, v154, v196
    v_mul_f32 v155, v155, v196
    v_mul_f32 v156, v156, v196
    v_mul_f32 v157, v157, v196
    v_mul_f32 v158, v158, v196
    v_mul_f32 v159, v159, v196
    v_cvt_pk_bf16_f32 v176, v64, v65
    v_cvt_pk_bf16_f32 v177, v66, v67
    v_cvt_pk_bf16_f32 v178, v68, v69
    v_cvt_pk_bf16_f32 v179, v70, v71
    v_cvt_pk_bf16_f32 v180, v72, v73
    v_cvt_pk_bf16_f32 v181, v74, v75
    v_cvt_pk_bf16_f32 v182, v76, v77
    v_cvt_pk_bf16_f32 v183, v78, v79
    v_cvt_pk_bf16_f32 v184, v80, v81
    v_cvt_pk_bf16_f32 v185, v82, v83
    v_cvt_pk_bf16_f32 v186, v84, v85
    v_cvt_pk_bf16_f32 v187, v86, v87
    v_cvt_pk_bf16_f32 v188, v88, v89
    v_cvt_pk_bf16_f32 v189, v90, v91
    v_cvt_pk_bf16_f32 v190, v92, v93
    v_cvt_pk_bf16_f32 v191, v94, v95
    s_nop 1
    s_waitcnt lgkmcnt(3)
    v_mfma_f32_32x32x16_bf16 v[96:111], v[160:163], v[176:179], v[96:111]
    ds_read_b128 v[160:163], v17 offset:0
    s_waitcnt lgkmcnt(3)
    v_mfma_f32_32x32x16_bf16 v[112:127], v[164:167], v[176:179], v[112:127]
    ds_read_b128 v[164:167], v17 offset:4096
    s_waitcnt lgkmcnt(3)
    v_mfma_f32_32x32x16_bf16 v[128:143], v[168:171], v[176:179], v[128:143]
    ds_read_b128 v[168:171], v17 offset:8192
    s_waitcnt lgkmcnt(3)
    v_mfma_f32_32x32x16_bf16 v[144:159], v[172:175], v[176:179], v[144:159]
    ds_read_b128 v[172:175], v17 offset:12288
    s_waitcnt lgkmcnt(3)
    v_mfma_f32_32x32x16_bf16 v[96:111], v[160:163], v[180:183], v[96:111]
    ds_read_b128 v[160:163], v18 offset:0
    s_waitcnt lgkmcnt(3)
    v_mfma_f32_32x32x16_bf16 v[112:127], v[164:167], v[180:183], v[112:127]
    ds_read_b128 v[164:167], v18 offset:4096
    s_waitcnt lgkmcnt(3)
    v_mfma_f32_32x32x16_bf16 v[128:143], v[168:171], v[180:183], v[128:143]
    ds_read_b128 v[168:171], v18 offset:8192
    s_waitcnt lgkmcnt(3)
    v_mfma_f32_32x32x16_bf16 v[144:159], v[172:175], v[180:183], v[144:159]
    ds_read_b128 v[172:175], v18 offset:12288
    s_waitcnt lgkmcnt(3)
    v_mfma_f32_32x32x16_bf16 v[96:111], v[160:163], v[184:187], v[96:111]
    ds_read_b128 v[160:163], v19 offset:0
    s_waitcnt lgkmcnt(3)
    v_mfma_f32_32x32x16_bf16 v[112:127], v[164:167], v[184:187], v[112:127]
    ds_read_b128 v[164:167], v19 offset:4096
    s_waitcnt lgkmcnt(3)
    v_mfma_f32_32x32x16_bf16 v[128:143], v[168:171], v[184:187], v[128:143]
    ds_read_b128 v[168:171], v19 offset:8192
    s_waitcnt lgkmcnt(3)
    v_mfma_f32_32x32x16_bf16 v[144:159], v[172:175], v[184:187], v[144:159]
    ds_read_b128 v[172:175], v19 offset:12288
    s_waitcnt lgkmcnt(3)
    v_mfma_f32_32x32x16_bf16 v[96:111], v[160:163], v[188:191], v[96:111]
    s_waitcnt lgkmcnt(2)
    v_mfma_f32_32x32x16_bf16 v[112:127], v[164:167], v[188:191], v[112:127]
    s_waitcnt lgkmcnt(1)
    v_mfma_f32_32x32x16_bf16 v[128:143], v[168:171], v[188:191], v[128:143]
    s_waitcnt lgkmcnt(0)
    v_mfma_f32_32x32x16_bf16 v[144:159], v[172:175], v[188:191], v[144:159]
    v_xor_b32 v8, 32768, v8
    v_xor_b32 v9, 32768, v9
    v_xor_b32 v10, 32768, v10
    v_xor_b32 v11, 32768, v11
    v_xor_b32 v12, 32768, v12
    v_xor_b32 v13, 32768, v13
    v_xor_b32 v14, 32768, v14
    v_xor_b32 v15, 32768, v15
    v_xor_b32 v16, 32768, v16
    v_xor_b32 v17, 32768, v17
    v_xor_b32 v18, 32768, v18
    v_xor_b32 v19, 32768, v19
    s_add_u32 s19, s19, 1
    s_branch k2_kernel_loop
k2_kernel_mloop:
    s_waitcnt vmcnt(0)
    s_barrier
    ds_read_b128 v[160:163], v8 offset:0
    ds_read_b128 v[164:167], v8 offset:8192
    ds_read_b128 v[168:171], v9 offset:0
    ds_read_b128 v[172:175], v9 offset:8192
    s_add_u32 s25, s19, 1
    s_cmp_ge_u32 s25, s18
    s_cbranch_scc1 k2_kernel_nodma_m
    s_add_u32 s25, s30, s31
    s_add_u32 m0, s25, 0
    s_nop 0
    buffer_load_dwordx4 v20, s[4:7], s16 offen lds
    s_add_u32 m0, s25, 1024
    s_nop 0
    buffer_load_dwordx4 v21, s[4:7], s16 offen lds
    s_add_u32 m0, s25, 2048
    s_nop 0
    buffer_load_dwordx4 v22, s[4:7], s16 offen lds
    s_add_u32 m0, s25, 3072
    s_nop 0
    buffer_load_dwordx4 v23, s[4:7], s16 offen lds
    s_add_u32 m0, s25, 16384
    s_nop 0
    buffer_load_dwordx4 v24, s[8:11], s17 offen lds
    s_add_u32 m0, s25, 17408
    s_nop 0
    buffer_load_dwordx4 v25, s[8:11], s17 offen lds
    s_add_u32 m0, s25, 18432
    s_nop 0
    buffer_load_dwordx4 v26, s[8:11], s17 offen lds
    s_add_u32 m0, s25, 19456
    s_nop 0
    buffer_load_dwordx4 v27, s[8:11], s17 offen lds
    s_add_u32 s16, s16, 524288
    s_add_u32 s17, s17, 128
    s_xor_b32 s30, s30, 32768
k2_kernel_nodma_m:
    s_waitcnt lgkmcnt(3)
    v_mfma_f32_32x32x16_bf16 v[64:79], v[160:163], v[32:35], 0
    ds_read_b128 v[160:163], v10 offset:0
    s_waitcnt lgkmcnt(3)
    v_mfma_f32_32x32x16_bf16 v[80:95], v[164:167], v[32:35], 0
    ds_read_b128 v[164:167], v10 offset:8192
    s_waitcnt lgkmcnt(3)
    v_mfma_f32_32x32x16_bf16 v[64:79], v[168:171], v[36:39], v[64:79]
    ds_read_b128 v[168:171], v11 offset:0
    s_waitcnt lgkmcnt(3)
    v_mfma_f32_32x32x16_bf16 v[80:95], v[172:175], v[36:39], v[80:95]
    ds_read_b128 v[172:175], v11 offset:8192
    s_waitcnt lgkmcnt(3)
    v_mfma_f32_32x32x16_bf16 v[64:79], v[160:163], v[40:43], v[64:79]
    ds_read_b128 v[160:163], v12 offset:0
    s_waitcnt lgkmcnt(3)
    v_mfma_f32_32x32x16_bf16 v[80:95], v[164:167], v[40:43], v[80:95]
    ds_read_b128 v[164:167], v12 offset:8192
    s_waitcnt lgkmcnt(3)
    v_mfma_f32_32x32x16_bf16 v[64:79], v[168:171], v[44:47], v[64:79]
    ds_read_b128 v[168:171], v13 offset:0
    s_waitcnt lgkmcnt(3)
    v_mfma_f32_32x32x16_bf16 v[80:95], v[172:175], v[44:47], v[80:95]
    ds_read_b128 v[172:175], v13 offset:8192
    s_waitcnt lgkmcnt(3)
    v_mfma_f32_32x32x16_bf16 v[64:79], v[160:163], v[48:51], v[64:79]
    ds_read_b128 v[160:163], v14 offset:0
    s_waitcnt lgkmcnt(3)
    v_mfma_f32_32x32x16_bf16 v[80:95], v[164:167], v[48:51], v[80:95]
    ds_read_b128 v[164:167], v14 offset:8192
    s_waitcnt lgkmcnt(3)
    v_mfma_f32_32x32x16_bf16 v[64:79], v[168:171], v[52:55], v[64:79]
    ds_read_b128 v[168:171], v15 offset:0
    s_waitcnt lgkmcnt(3)
    v_mfma_f32_32x32x16_bf16 v[80:95], v[172:175], v[52:55], v[80:95]
    ds_read_b128 v[172:175], v15 offset:8192
    s_waitcnt lgkmcnt(3)
    v_mfma_f32_32x32x16_bf16 v[64:79], v[160:163], v[56:59], v[64:79]
    s_waitcnt lgkmcnt(2)
    v_mfma_f32_32x32x16_bf16 v[80:95], v[164:167], v[56:59], v[80:95]
    s_waitcnt lgkmcnt(1)
    v_mfma_f32_32x32x16_bf16 v[64:79], v[168:171], v[60:63], v[64:79]
    s_waitcnt lgkmcnt(0)
    v_mfma_f32_32x32x16_bf16 v[80:95], v[172:175], v[60:63], v[80:95]
    ds_read_b128 v[160:163], v16 offset:0
    ds_read_b128 v[164:167], v16 offset:4096
    ds_read_b128 v[168:171], v16 offset:8192
    ds_read_b128 v[172:175], v16 offset:12288
    s_nop 7
    s_nop 7
    s_lshl_b32 s25, s19, 6
    v_subrev_u32 v194, s25, v198
    v_mov_b32 v195, 0xff800000
    v_cmp_gt_i32 vcc, 0, v194
    s_nop 1
    v_cndmask_b32 v64, v64, v195, vcc
    v_cmp_gt_i32 vcc, 1, v194
    s_nop 1
    v_cndmask_b32 v65, v65, v195, vcc
    v_cmp_gt_i32 vcc, 2, v194
    s_nop 1
    v_cndmask_b32 v66, v66, v195, vcc
    v_cmp_gt_i32 vcc, 3, v194
    s_nop 1
    v_cndmask_b32 v67, v67, v195, vcc
    v_cmp_gt_i32 vcc, 8, v194
    s_nop 1
    v_cndmask_b32 v68, v68, v195, vcc
    v_cmp_gt_i32 vcc, 9, v194
    s_nop 1
    v_cndmask_b32 v69, v69, v195, vcc
    v_cmp_gt_i32 vcc, 10, v194
    s_nop 1
    v_cndmask_b32 v70, v70, v195, vcc
    v_cmp_gt_i32 vcc, 11, v194
    s_nop 1
    v_cndmask_b32 v71, v71, v195, vcc
    v_cmp_gt_i32 vcc, 16, v194
    s_nop 1
    v_cndmask_b32 v72, v72, v195, vcc
    v_cmp_gt_i32 vcc, 17, v194
    s_nop 1
    v_cndmask_b32 v73, v73, v195, vcc
    v_cmp_gt_i32 vcc, 18, v194
    s_nop 1
    v_cndmask_b32 v74, v74, v195, vcc
    v_cmp_gt_i32 vcc, 19, v194
    s_nop 1
    v_cndmask_b32 v75, v75, v195, vcc
    v_cmp_gt_i32 vcc, 24, v194
    s_nop 1
    v_cndmask_b32 v76, v76, v195, vcc
    v_cmp_gt_i32 vcc, 25, v194
    s_nop 1
    v_cndmask_b32 v77, v77, v195, vcc
    v_cmp_gt_i32 vcc, 26, v194
    s_nop 1
    v_cndmask_b32 v78, v78, v195, vcc
    v_cmp_gt_i32 vcc, 27, v194
    s_nop 1
    v_cndmask_b32 v79, v79, v195, vcc
    v_cmp_gt_i32 vcc, 32, v194
    s_nop 1
    v_cndmask_b32 v80, v80, v195, vcc
    v_cmp_gt_i32 vcc, 33, v194
    s_nop 1
    v_cndmask_b32 v81, v81, v195, vcc
    v_cmp_gt_i32 vcc, 34, v194
    s_nop 1
    v_cndmask_b32 v82, v82, v195, vcc
    v_cmp_gt_i32 vcc, 35, v194
    s_nop 1
    v_cndmask_b32 v83, v83, v195, vcc
    v_cmp_gt_i32 vcc, 40, v194
    s_nop 1
    v_cndmask_b32 v84, v84, v195, vcc
    v_cmp_gt_i32 vcc, 41, v194
    s_nop 1
    v_cndmask_b32 v85, v85, v195, vcc
    v_cmp_gt_i32 vcc, 42, v194
    s_nop 1
    v_cndmask_b32 v86, v86, v195, vcc
    v_cmp_gt_i32 vcc, 43, v194
    s_nop 1
    v_cndmask_b32 v87, v87, v195, vcc
    v_cmp_gt_i32 vcc, 48, v194
    s_nop 1
    v_cndmask_b32 v88, v88, v195, vcc
    v_cmp_gt_i32 vcc, 49, v194
    s_nop 1
    v_cndmask_b32 v89, v89, v195, vcc
    v_cmp_gt_i32 vcc, 50, v194
    s_nop 1
    v_cndmask_b32 v90, v90, v195, vcc
    v_cmp_gt_i32 vcc, 51, v194
    s_nop 1
    v_cndmask_b32 v91, v91, v195, vcc
    v_cmp_gt_i32 vcc, 56, v194
    s_nop 1
    v_cndmask_b32 v92, v92, v195, vcc
    v_cmp_gt_i32 vcc, 57, v194
    s_nop 1
    v_cndmask_b32 v93, v93, v195, vcc
    v_cmp_gt_i32 vcc, 58, v194
    s_nop 1
    v_cndmask_b32 v94, v94, v195, vcc
    v_cmp_gt_i32 vcc, 59, v194
    s_nop 1
    v_cndmask_b32 v95, v95, v195, vcc
    v_max3_f32 v194, v64, v65, v66
    v_max3_f32 v194, v194, v67, v68
    v_max3_f32 v194, v194, v69, v70
    v_max3_f32 v194, v194, v71, v72
    v_max3_f32 v194, v194, v73, v74
    v_max3_f32 v194, v194, v75, v76
    v_max3_f32 v194, v194, v77, v78
    v_max3_f32 v194, v194, v79, v80
    v_max3_f32 v194, v194, v81, v82
    v_max3_f32 v194, v194, v83, v84
    v_max3_f32 v194, v194, v85, v86
    v_max3_f32 v194, v194, v87, v88
    v_max3_f32 v194, v194, v89, v90
    v_max3_f32 v194, v194, v91, v92
    v_max3_f32 v194, v194, v93, v94
    v_max_f32 v194, v194, v95
    v_mov_b32 v195, v194
    s_nop 1
    v_permlane32_swap_b32 v194, v195
    s_nop 1
    v_max3_f32 v194, v194, v195, v192
    v_sub_f32 v196, v192, v194
    v_mul_f32 v196, s21, v196
    v_exp_f32 v196, v196
    v_mov_b32 v192, v194
    v_mul_f32 v197, s21, v194
    v_sub_f32 v197, 0, v197
    v_fma_f32 v64, v64, s21, v197
    v_fma_f32 v65, v65, s21, v197
    v_fma_f32 v66, v66, s21, v197
    v_fma_f32 v67, v67, s21, v197
    v_fma_f32 v68, v68, s21, v197
    v_fma_f32 v69, v69, s21, v197
    v_fma_f32 v70, v70, s21, v197
    v_fma_f32 v71, v71, s21, v197
    v_fma_f32 v72, v72, s21, v197
    v_fma_f32 v73, v73, s21, v197
    v_fma_f32 v74, v74, s21, v197
    v_fma_f32 v75, v75, s21, v197
    v_fma_f32 v76, v76, s21, v197
    v_fma_f32 v77, v77, s21, v197
    v_fma_f32 v78, v78, s21, v197
    v_fma_f32 v79, v79, s21, v197
    v_fma_f32 v80, v80, s21, v197
    v_fma_f32 v81, v81, s21, v197
    v_fma_f32 v82, v82, s21, v197
    v_fma_f32 v83, v83, s21, v197
    v_fma_f32 v84, v84, s21, v197
    v_fma_f32 v85, v85, s21, v197
    v_fma_f32 v86, v86, s21, v197
    v_fma_f32 v87, v87, s21, v197
    v_fma_f32 v88, v88, s21, v197
    v_fma_f32 v89, v89, s21, v197
    v_fma_f32 v90, v90, s21, v197
    v_fma_f32 v91, v91, s21, v197
    v_fma_f32 v92, v92, s21, v197
    v_fma_f32 v93, v93, s21, v197
    v_fma_f32 v94, v94, s21, v197
    v_fma_f32 v95, v95, s21, v197
    v_exp_f32 v64, v64
    v_exp_f32 v65, v65
    v_exp_f32 v66, v66
    v_exp_f32 v67, v67
    v_exp_f32 v68, v68
    v_exp_f32 v69, v69
    v_exp_f32 v70, v70
    v_exp_f32 v71, v71
    v_exp_f32 v72, v72
    v_exp_f32 v73, v73
    v_exp_f32 v74, v74
    v_exp_f32 v75, v75
    v_exp_f32 v76, v76
    v_exp_f32 v77, v77
    v_exp_f32 v78, v78
    v_exp_f32 v79, v79
    v_exp_f32 v80, v80
    v_exp_f32 v81, v81
    v_exp_f32 v82, v82
    v_exp_f32 v83, v83
    v_exp_f32 v84, v84
    v_exp_f32 v85, v85
    v_exp_f32 v86, v86
    v_exp_f32 v87, v87
    v_exp_f32 v88, v88
    v_exp_f32 v89, v89
    v_exp_f32 v90, v90
    v_exp_f32 v91, v91
    v_exp_f32 v92, v92
    v_exp_f32 v93, v93
    v_exp_f32 v94, v94
    v_exp_f32 v95, v95
    v_mul_f32 v193, v193, v196
    v_add_f32 v193, v193, v64
    v_add_f32 v193, v193, v65
    v_add_f32 v193, v193, v66
    v_add_f32 v193, v193, v67
    v_add_f32 v193, v193, v68
    v_add_f32 v193, v193, v69
    v_add_f32 v193, v193, v70
    v_add_f32 v193, v193, v71
    v_add_f32 v193, v193, v72
    v_add_f32 v193, v193, v73
    v_add_f32 v193, v193, v74
    v_add_f32 v193, v193, v75
    v_add_f32 v193, v193, v76
    v_add_f32 v193, v193, v77
    v_add_f32 v193, v193, v78
    v_add_f32 v193, v193, v79
    v_add_f32 v193, v193, v80
    v_add_f32 v193, v193, v81
    v_add_f32 v193, v193, v82
    v_add_f32 v193, v193, v83
    v_add_f32 v193, v193, v84
    v_add_f32 v193, v193, v85
    v_add_f32 v193, v193, v86
    v_add_f32 v193, v193, v87
    v_add_f32 v193, v193, v88
    v_add_f32 v193, v193, v89
    v_add_f32 v193, v193, v90
    v_add_f32 v193, v193, v91
    v_add_f32 v193, v193, v92
    v_add_f32 v193, v193, v93
    v_add_f32 v193, v193, v94
    v_add_f32 v193, v193, v95
    v_mul_f32 v96, v96, v196
    v_mul_f32 v97, v97, v196
    v_mul_f32 v98, v98, v196
    v_mul_f32 v99, v99, v196
    v_mul_f32 v100, v100, v196
    v_mul_f32 v101, v101, v196
    v_mul_f32 v102, v102, v196
    v_mul_f32 v103, v103, v196
    v_mul_f32 v104, v104, v196
    v_mul_f32 v105, v105, v196
    v_mul_f32 v106, v106, v196
    v_mul_f32 v107, v107, v196
    v_mul_f32 v108, v108, v196
    v_mul_f32 v109, v109, v196
    v_mul_f32 v110, v110, v196
    v_mul_f32 v111, v111, v196
    v_mul_f32 v112, v112, v196
    v_mul_f32 v113, v113, v196
    v_mul_f32 v114, v114, v196
    v_mul_f32 v115, v115, v196
    v_mul_f32 v116, v116, v196
    v_mul_f32 v117, v117, v196
    v_mul_f32 v118, v118, v196
    v_mul_f32 v119, v119, v196
    v_mul_f32 v120, v120, v196
    v_mul_f32 v121, v121, v196
    v_mul_f32 v122, v122, v196
    v_mul_f32 v123, v123, v196
    v_mul_f32 v124, v124, v196
    v_mul_f32 v125, v125, v196
    v_mul_f32 v126, v126, v196
    v_mul_f32 v127, v127, v196
    v_mul_f32 v128, v128, v196
    v_mul_f32 v129, v129, v196
    v_mul_f32 v130, v130, v196
    v_mul_f32 v131, v131, v196
    v_mul_f32 v132, v132, v196
    v_mul_f32 v133, v133, v196
    v_mul_f32 v134, v134, v196
    v_mul_f32 v135, v135, v196
    v_mul_f32 v136, v136, v196
    v_mul_f32 v137, v137, v196
    v_mul_f32 v138, v138, v196
    v_mul_f32 v139, v139, v196
    v_mul_f32 v140, v140, v196
    v_mul_f32 v141, v141, v196
    v_mul_f32 v142, v142, v196
    v_mul_f32 v143, v143, v196
    v_mul_f32 v144, v144, v196
    v_mul_f32 v145, v145, v196
    v_mul_f32 v146, v146, v196
    v_mul_f32 v147, v147, v196
    v_mul_f32 v148, v148, v196
    v_mul_f32 v149, v149, v196
    v_mul_f32 v150, v150, v196
    v_mul_f32 v151, v151, v196
    v_mul_f32 v152, v152, v196
    v_mul_f32 v153, v153, v196
    v_mul_f32 v154, v154, v196
    v_mul_f32 v155, v155, v196
    v_mul_f32 v156, v156, v196
    v_mul_f32 v157, v157, v196
    v_mul_f32 v158, v158, v196
    v_mul_f32 v159, v159, v196
    v_cvt_pk_bf16_f32 v176, v64, v65
    v_cvt_pk_bf16_f32 v177, v66, v67
    v_cvt_pk_bf16_f32 v178, v68, v69
    v_cvt_pk_bf16_f32 v179, v70, v71
    v_cvt_pk_bf16_f32 v180, v72, v73
    v_cvt_pk_bf16_f32 v181, v74, v75
    v_cvt_pk_bf16_f32 v182, v76, v77
    v_cvt_pk_bf16_f32 v183, v78, v79
    v_cvt_pk_bf16_f32 v184, v80, v81
    v_cvt_pk_bf16_f32 v185, v82, v83
    v_cvt_pk_bf16_f32 v186, v84, v85
    v_cvt_pk_bf16_f32 v187, v86, v87
    v_cvt_pk_bf16_f32 v188, v88, v89
    v_cvt_pk_bf16_f32 v189, v90, v91
    v_cvt_pk_bf16_f32 v190, v92, v93
    v_cvt_pk_bf16_f32 v191, v94, v95
    s_nop 1
    s_waitcnt lgkmcnt(3)
    v_mfma_f32_32x32x16_bf16 v[96:111], v[160:163], v[176:179], v[96:111]
    ds_read_b128 v[160:163], v17 offset:0
    s_waitcnt lgkmcnt(3)
    v_mfma_f32_32x32x16_bf16 v[112:127], v[164:167], v[176:179], v[112:127]
    ds_read_b128 v[164:167], v17 offset:4096
    s_waitcnt lgkmcnt(3)
    v_mfma_f32_32x32x16_bf16 v[128:143], v[168:171], v[176:179], v[128:143]
    ds_read_b128 v[168:171], v17 offset:8192
    s_waitcnt lgkmcnt(3)
    v_mfma_f32_32x32x16_bf16 v[144:159], v[172:175], v[176:179], v[144:159]
    ds_read_b128 v[172:175], v17 offset:12288
    s_waitcnt lgkmcnt(3)
    v_mfma_f32_32x32x16_bf16 v[96:111], v[160:163], v[180:183], v[96:111]
    ds_read_b128 v[160:163], v18 offset:0
    s_waitcnt lgkmcnt(3)
    v_mfma_f32_32x32x16_bf16 v[112:127], v[164:167], v[180:183], v[112:127]
    ds_read_b128 v[164:167], v18 offset:4096
    s_waitcnt lgkmcnt(3)
    v_mfma_f32_32x32x16_bf16 v[128:143], v[168:171], v[180:183], v[128:143]
    ds_read_b128 v[168:171], v18 offset:8192
    s_waitcnt lgkmcnt(3)
    v_mfma_f32_32x32x16_bf16 v[144:159], v[172:175], v[180:183], v[144:159]
    ds_read_b128 v[172:175], v18 offset:12288
    s_waitcnt lgkmcnt(3)
    v_mfma_f32_32x32x16_bf16 v[96:111], v[160:163], v[184:187], v[96:111]
    ds_read_b128 v[160:163], v19 offset:0
    s_waitcnt lgkmcnt(3)
    v_mfma_f32_32x32x16_bf16 v[112:127], v[164:167], v[184:187], v[112:127]
    ds_read_b128 v[164:167], v19 offset:4096
    s_waitcnt lgkmcnt(3)
    v_mfma_f32_32x32x16_bf16 v[128:143], v[168:171], v[184:187], v[128:143]
    ds_read_b128 v[168:171], v19 offset:8192
    s_waitcnt lgkmcnt(3)
    v_mfma_f32_32x32x16_bf16 v[144:159], v[172:175], v[184:187], v[144:159]
    ds_read_b128 v[172:175], v19 offset:12288
    s_waitcnt lgkmcnt(3)
    v_mfma_f32_32x32x16_bf16 v[96:111], v[160:163], v[188:191], v[96:111]
    s_waitcnt lgkmcnt(2)
    v_mfma_f32_32x32x16_bf16 v[112:127], v[164:167], v[188:191], v[112:127]
    s_waitcnt lgkmcnt(1)
    v_mfma_f32_32x32x16_bf16 v[128:143], v[168:171], v[188:191], v[128:143]
    s_waitcnt lgkmcnt(0)
    v_mfma_f32_32x32x16_bf16 v[144:159], v[172:175], v[188:191], v[144:159]
    v_xor_b32 v8, 32768, v8
    v_xor_b32 v9, 32768, v9
    v_xor_b32 v10, 32768, v10
    v_xor_b32 v11, 32768, v11
    v_xor_b32 v12, 32768, v12
    v_xor_b32 v13, 32768, v13
    v_xor_b32 v14, 32768, v14
    v_xor_b32 v15, 32768, v15
    v_xor_b32 v16, 32768, v16
    v_xor_b32 v17, 32768, v17
    v_xor_b32 v18, 32768, v18
    v_xor_b32 v19, 32768, v19
    s_add_u32 s19, s19, 1
    s_cmp_lt_u32 s19, s18
    s_cbranch_scc1 k2_kernel_mloop
    v_mov_b32 v194, v193
    s_nop 1
    v_permlane32_swap_b32 v193, v194
    s_nop 1
    v_add_f32 v193, v193, v194
    v_rcp_f32 v193, v193
    s_nop 0
    v_mul_f32 v96, v96, v193
    v_mul_f32 v97, v97, v193
    v_mul_f32 v98, v98, v193
    v_mul_f32 v99, v99, v193
    v_mul_f32 v100, v100, v193
    v_mul_f32 v101, v101, v193
    v_mul_f32 v102, v102, v193
    v_mul_f32 v103, v103, v193
    v_mul_f32 v104, v104, v193
    v_mul_f32 v105, v105, v193
    v_mul_f32 v106, v106, v193
    v_mul_f32 v107, v107, v193
    v_mul_f32 v108, v108, v193
    v_mul_f32 v109, v109, v193
    v_mul_f32 v110, v110, v193
    v_mul_f32 v111, v111, v193
    v_mul_f32 v112, v112, v193
    v_mul_f32 v113, v113, v193
    v_mul_f32 v114, v114, v193
    v_mul_f32 v115, v115, v193
    v_mul_f32 v116, v116, v193
    v_mul_f32 v117, v117, v193
    v_mul_f32 v118, v118, v193
    v_mul_f32 v119, v119, v193
    v_mul_f32 v120, v120, v193
    v_mul_f32 v121, v121, v193
    v_mul_f32 v122, v122, v193
    v_mul_f32 v123, v123, v193
    v_mul_f32 v124, v124, v193
    v_mul_f32 v125, v125, v193
    v_mul_f32 v126, v126, v193
    v_mul_f32 v127, v127, v193
    v_mul_f32 v128, v128, v193
    v_mul_f32 v129, v129, v193
    v_mul_f32 v130, v130, v193
    v_mul_f32 v131, v131, v193
    v_mul_f32 v132, v132, v193
    v_mul_f32 v133, v133, v193
    v_mul_f32 v134, v134, v193
    v_mul_f32 v135, v135, v193
    v_mul_f32 v136, v136, v193
    v_mul_f32 v137, v137, v193
    v_mul_f32 v138, v138, v193
    v_mul_f32 v139, v139, v193
    v_mul_f32 v140, v140, v193
    v_mul_f32 v141, v141, v193
    v_mul_f32 v142, v142, v193
    v_mul_f32 v143, v143, v193
    v_mul_f32 v144, v144, v193
    v_mul_f32 v145, v145, v193
    v_mul_f32 v146, v146, v193
    v_mul_f32 v147, v147, v193
    v_mul_f32 v148, v148, v193
    v_mul_f32 v149, v149, v193
    v_mul_f32 v150, v150, v193
    v_mul_f32 v151, v151, v193
    v_mul_f32 v152, v152, v193
    v_mul_f32 v153, v153, v193
    v_mul_f32 v154, v154, v193
    v_mul_f32 v155, v155, v193
    v_mul_f32 v156, v156, v193
    v_mul_f32 v157, v157, v193
    v_mul_f32 v158, v158, v193
    v_mul_f32 v159, v159, v193
    v_lshlrev_b32 v3, 13, v3
    v_lshl_add_u32 v3, v5, 3, v3
    s_lshl_b32 s25, s35, 8
    v_cvt_pk_bf16_f32 v96, v96, v97
    v_cvt_pk_bf16_f32 v97, v98, v99
    buffer_store_dwordx2 v[96:97], v3, s[40:43], s25 offen offset:0
    v_cvt_pk_bf16_f32 v100, v100, v101
    v_cvt_pk_bf16_f32 v101, v102, v103
    buffer_store_dwordx2 v[100:101], v3, s[40:43], s25 offen offset:16
    v_cvt_pk_bf16_f32 v104, v104, v105
    v_cvt_pk_bf16_f32 v105, v106, v107
    buffer_store_dwordx2 v[104:105], v3, s[40:43], s25 offen offset:32
    v_cvt_pk_bf16_f32 v108, v108, v109
    v_cvt_pk_bf16_f32 v109, v110, v111
    buffer_store_dwordx2 v[108:109], v3, s[40:43], s25 offen offset:48
    v_cvt_pk_bf16_f32 v112, v112, v113
    v_cvt_pk_bf16_f32 v113, v114, v115
    buffer_store_dwordx2 v[112:113], v3, s[40:43], s25 offen offset:64
    v_cvt_pk_bf16_f32 v116, v116, v117
    v_cvt_pk_bf16_f32 v117, v118, v119
    buffer_store_dwordx2 v[116:117], v3, s[40:43], s25 offen offset:80
    v_cvt_pk_bf16_f32 v120, v120, v121
    v_cvt_pk_bf16_f32 v121, v122, v123
    buffer_store_dwordx2 v[120:121], v3, s[40:43], s25 offen offset:96
    v_cvt_pk_bf16_f32 v124, v124, v125
    v_cvt_pk_bf16_f32 v125, v126, v127
    buffer_store_dwordx2 v[124:125], v3, s[40:43], s25 offen offset:112
    v_cvt_pk_bf16_f32 v128, v128, v129
    v_cvt_pk_bf16_f32 v129, v130, v131
    buffer_store_dwordx2 v[128:129], v3, s[40:43], s25 offen offset:128
    v_cvt_pk_bf16_f32 v132, v132, v133
    v_cvt_pk_bf16_f32 v133, v134, v135
    buffer_store_dwordx2 v[132:133], v3, s[40:43], s25 offen offset:144
    v_cvt_pk_bf16_f32 v136, v136, v137
    v_cvt_pk_bf16_f32 v137, v138, v139
    buffer_store_dwordx2 v[136:137], v3, s[40:43], s25 offen offset:160
    v_cvt_pk_bf16_f32 v140, v140, v141
    v_cvt_pk_bf16_f32 v141, v142, v143
    buffer_store_dwordx2 v[140:141], v3, s[40:43], s25 offen offset:176
    v_cvt_pk_bf16_f32 v144, v144, v145
    v_cvt_pk_bf16_f32 v145, v146, v147
    buffer_store_dwordx2 v[144:145], v3, s[40:43], s25 offen offset:192
    v_cvt_pk_bf16_f32 v148, v148, v149
    v_cvt_pk_bf16_f32 v149, v150, v151
    buffer_store_dwordx2 v[148:149], v3, s[40:43], s25 offen offset:208
    v_cvt_pk_bf16_f32 v152, v152, v153
    v_cvt_pk_bf16_f32 v153, v154, v155
    buffer_store_dwordx2 v[152:153], v3, s[40:43], s25 offen offset:224
    v_cvt_pk_bf16_f32 v156, v156, v157
    v_cvt_pk_bf16_f32 v157, v158, v159
    buffer_store_dwordx2 v[156:157], v3, s[40:43], s25 offen offset:240
    s_waitcnt vmcnt(0)
k2_kernel_end:
    s_endpgm
.section .rodata,"a"
.p2align 6
.amdhsa_kernel k2_kernel
  .amdhsa_next_free_vgpr 200
  .amdhsa_next_free_sgpr 102
  .amdhsa_accum_offset 200
  .amdhsa_group_segment_fixed_size 0
  .amdhsa_kernarg_size 104
  .amdhsa_user_sgpr_count 2
  .amdhsa_user_sgpr_kernarg_segment_ptr 1
  .amdhsa_system_sgpr_workgroup_id_x 1
.end_amdhsa_kernel
.text
.globl k3_kernel
.p2align 8
.type k3_kernel,@function
k3_kernel:
    s_cmp_ge_u32 s2, 240
    s_cbranch_scc1 k3_kernel_end
    s_load_dwordx2 s[32:33], s[0:1], 96
    s_load_dwordx2 s[26:27], s[0:1], 40
    s_load_dwordx2 s[28:29], s[0:1], 64
    s_and_b32 s35, s2, 7
    s_lshr_b32 s36, s2, 3
    s_and_b32 s37, s36, 1
    s_lshl_b32 s37, s37, 3
    s_add_u32 s35, s35, s37
    s_lshr_b32 s36, s36, 1
    s_mul_i32 s34, s36, 21846
    s_lshr_b32 s34, s34, 16
    s_mul_i32 s37, s34, 3
    s_sub_u32 s36, s36, s37
    s_waitcnt lgkmcnt(0)
    s_cmp_lt_u32 s34, 2
    s_mov_b32 s41, 50331648
    s_cselect_b32 s40, 75497472, s41
    s_add_u32 s4, s32, s40
    s_addc_u32 s5, s33, 0
    s_cmp_lt_u32 s34, 2
    s_mov_b32 s41, 18874368
    s_cselect_b32 s6, 16777216, s41
    s_mov_b32 s7, 0x00020000
    s_mov_b32 s41, 9216
    s_cselect_b32 s19, 8192, s41
    s_cselect_b32 s8, s26, s28
    s_cselect_b32 s9, s27, s29
    s_mov_b32 s41, 5308416
    s_cselect_b32 s10, 4718592, s41
    s_mov_b32 s11, 0x00020000
    s_cselect_b32 s18, 32, 24
    s_sub_u32 s41, s34, 2
    s_cselect_b32 s41, s34, s41
    s_mul_i32 s41, s41, s18
    s_mov_b32 s20, 1152
    s_mov_b32 s23, 73728
    s_mul_i32 s16, s35, 128
    s_mul_i32 s16, s16, s19
    s_lshl_b32 s25, s41, 7
    s_add_u32 s16, s16, s25
    s_mul_i32 s17, s41, s23
    s_mul_i32 s25, s36, 384
    s_add_u32 s17, s17, s25
    s_mul_i32 s25, s34, 4718592
    s_add_u32 s25, s25, 100663296
    s_add_u32 s12, s32, s25
    s_addc_u32 s13, s33, 0
    s_mov_b32 s14, 4718592
    s_mov_b32 s15, 0x00020000
    s_movk_i32 s21, 2304
    s_mul_i32 s28, s35, 294912
    s_mul_i32 s25, s36, 768
    s_add_u32 s28, s28, s25
    v_and_b32 v1, 63, v0
    v_lshrrev_b32 v2, 6, v0
    s_nop 0
    v_readfirstlane_b32 s22, v2
    v_lshrrev_b32 v3, 3, v1
    v_mul_u32_u24 v4, 32, v2
    v_add_u32 v3, v3, v4
    v_and_b32 v4, 7, v1
    v_add_u32 v5, 0, v3
    v_lshrrev_b32 v6, 1, v5
    v_and_b32 v6, 7, v6
    v_xor_b32 v6, v4, v6
    v_mul_lo_u32 v5, v5, s19
    v_lshl_add_u32 v8, v6, 4, v5
    v_add_u32 v5, 8, v3
    v_lshrrev_b32 v6, 1, v5
    v_and_b32 v6, 7, v6
    v_xor_b32 v6, v4, v6
    v_mul_lo_u32 v5, v5, s19
    v_lshl_add_u32 v9, v6, 4, v5
    v_add_u32 v5, 16, v3
    v_lshrrev_b32 v6, 1, v5
    v_and_b32 v6, 7, v6
    v_xor_b32 v6, v4, v6
    v_mul_lo_u32 v5, v5, s19
    v_lshl_add_u32 v10, v6, 4, v5
    v_add_u32 v5, 24, v3
    v_lshrrev_b32 v6, 1, v5
    v_and_b32 v6, 7, v6
    v_xor_b32 v6, v4, v6
    v_mul_lo_u32 v5, v5, s19
    v_lshl_add_u32 v11, v6, 4, v5
    v_mul_u32_u24 v3, 384, v2
    v_add_u32 v3, v3, v1
    s_movk_i32 s25, 2731
    v_add_u32 v4, 0, v3
    v_mul_lo_u32 v5, v4, s25
    v_lshrrev_b32 v5, 16, v5
    v_mul_u32_u24 v6, 24, v5
    v_sub_u32 v4, v4, v6
    v_lshrrev_b32 v6, 2, v4
    v_lshrrev_b32 v7, 1, v5
    v_and_b32 v7, 1, v7
    v_xor_b32 v6, v6, v7
    v_and_b32 v4, 3, v4
    v_lshl_add_u32 v4, v6, 2, v4
    v_mul_lo_u32 v5, v5, s20
    v_lshl_add_u32 v12, v4, 4, v5
    v_add_u32 v4, 64, v3
    v_mul_lo_u32 v5, v4, s25
    v_lshrrev_b32 v5, 16, v5
    v_mul_u32_u24 v6, 24, v5
    v_sub_u32 v4, v4, v6
    v_lshrrev_b32 v6, 2, v4
    v_lshrrev_b32 v7, 1, v5
    v_and_b32 v7, 1, v7
    v_xor_b32 v6, v6, v7
    v_and_b32 v4, 3, v4
    v_lshl_add_u32 v4, v6, 2, v4
    v_mul_lo_u32 v5, v5, s20
    v_lshl_add_u32 v13, v4, 4, v5
    v_add_u32 v4, 128, v3
    v_mul_lo_u32 v5, v4, s25
    v_lshrrev_b32 v5, 16, v5
    v_mul_u32_u24 v6, 24, v5
    v_sub_u32 v4, v4, v6
    v_lshrrev_b32 v6, 2, v4
    v_lshrrev_b32 v7, 1, v5
    v_and_b32 v7, 1, v7
    v_xor_b32 v6, v6, v7
    v_and_b32 v4, 3, v4
    v_lshl_add_u32 v4, v6, 2, v4
    v_mul_lo_u32 v5, v5, s20
    v_lshl_add_u32 v14, v4, 4, v5
    v_add_u32 v4, 192, v3
    v_mul_lo_u32 v5, v4, s25
    v_lshrrev_b32 v5, 16, v5
    v_mul_u32_u24 v6, 24, v5
    v_sub_u32 v4, v4, v6
    v_lshrrev_b32 v6, 2, v4
    v_lshrrev_b32 v7, 1, v5
    v_and_b32 v7, 1, v7
    v_xor_b32 v6, v6, v7
    v_and_b32 v4, 3, v4
    v_lshl_add_u32 v4, v6, 2, v4
    v_mul_lo_u32 v5, v5, s20
    v_lshl_add_u32 v15, v4, 4, v5
    v_add_u32 v4, 256, v3
    v_mul_lo_u32 v5, v4, s25
    v_lshrrev_b32 v5, 16, v5
    v_mul_u32_u24 v6, 24, v5
    v_sub_u32 v4, v4, v6
    v_lshrrev_b32 v6, 2, v4
    v_lshrrev_b32 v7, 1, v5
    v_and_b32 v7, 1, v7
    v_xor_b32 v6, v6, v7
    v_and_b32 v4, 3, v4
    v_lshl_add_u32 v4, v6, 2, v4
    v_mul_lo_u32 v5, v5, s20
    v_lshl_add_u32 v16, v4, 4, v5
    v_add_u32 v4, 320, v3
    v_mul_lo_u32 v5, v4, s25
    v_lshrrev_b32 v5, 16, v5
    v_mul_u32_u24 v6, 24, v5
    v_sub_u32 v4, v4, v6
    v_lshrrev_b32 v6, 2, v4
    v_lshrrev_b32 v7, 1, v5
    v_and_b32 v7, 1, v7
    v_xor_b32 v6, v6, v7
    v_and_b32 v4, 3, v4
    v_lshl_add_u32 v4, v6, 2, v4
    v_mul_lo_u32 v5, v5, s20
    v_lshl_add_u32 v17, v4, 4, v5
    v_and_b32 v3, 31, v1
    v_lshrrev_b32 v4, 1, v2
    v_mul_u32_u24 v4, 64, v4
    v_add_u32 v3, v3, v4
    v_lshrrev_b32 v5, 5, v1
    v_lshrrev_b32 v6, 1, v3
    v_and_b32 v6, 7, v6
    v_lshlrev_b32 v7, 7, v3
    v_add_u32 v32, 0, v5
    v_xor_b32 v32, v32, v6
    v_lshl_add_u32 v18, v32, 4, v7
    v_add_u32 v32, 2, v5
    v_xor_b32 v32, v32, v6
    v_lshl_add_u32 v19, v32, 4, v7
    v_add_u32 v32, 4, v5
    v_xor_b32 v32, v32, v6
    v_lshl_add_u32 v20, v32, 4, v7
    v_add_u32 v32, 6, v5
    v_xor_b32 v32, v32, v6
    v_lshl_add_u32 v21, v32, 4, v7
    v_and_b32 v3, 15, v1
    v_lshrrev_b32 v4, 2, v3
    v_lshl_add_u32 v6, v5, 3, v4
    v_mul_u32_u24 v6, 384, v6
    v_and_b32 v7, 3, v3
    v_lshl_add_u32 v6, v7, 3, v6
    v_lshrrev_b32 v7, 4, v1
    v_and_b32 v7, 1, v7
    v_lshl_add_u32 v6, v7, 5, v6
    v_add_u32 v6, 16384, v6
    v_lshrrev_b32 v4, 3, v3
    v_and_b32 v7, 1, v2
    v_mul_u32_u24 v7, 3, v7
    v_add_u32 v32, 0, v7
    v_xor_b32 v32, v32, v4
    v_lshl_add_u32 v26, v32, 6, v6
    v_add_u32 v32, 1, v7
    v_xor_b32 v32, v32, v4
    v_lshl_add_u32 v27, v32, 6, v6
    v_add_u32 v32, 2, v7
    v_xor_b32 v32, v32, v4
    v_lshl_add_u32 v28, v32, 6, v6
    v_add_u32 v22, 40960, v18
    v_add_u32 v23, 40960, v19
    v_add_u32 v24, 40960, v20
    v_add_u32 v25, 40960, v21
    v_add_u32 v29, 40960, v26
    v_add_u32 v30, 40960, v27
    v_add_u32 v31, 40960, v28
    v_mov_b32 v72, 0
    v_mov_b32 v73, 0
    v_mov_b32 v74, 0
    v_mov_b32 v75, 0
    v_mov_b32 v76, 0
    v_mov_b32 v77, 0
    v_mov_b32 v78, 0
    v_mov_b32 v79, 0
    v_mov_b32 v80, 0
    v_mov_b32 v81, 0
    v_mov_b32 v82, 0
    v_mov_b32 v83, 0
    v_mov_b32 v84, 0
    v_mov_b32 v85, 0
    v_mov_b32 v86, 0
    v_mov_b32 v87, 0
    v_mov_b32 v88, 0
    v_mov_b32 v89, 0
    v_mov_b32 v90, 0
    v_mov_b32 v91, 0
    v_mov_b32 v92, 0
    v_mov_b32 v93, 0
    v_mov_b32 v94, 0
    v_mov_b32 v95, 0
    v_mov_b32 v96, 0
    v_mov_b32 v97, 0
    v_mov_b32 v98, 0
    v_mov_b32 v99, 0
    v_mov_b32 v100, 0
    v_mov_b32 v101, 0
    v_mov_b32 v102, 0
    v_mov_b32 v103, 0
    v_mov_b32 v104, 0
    v_mov_b32 v105, 0
    v_mov_b32 v106, 0
    v_mov_b32 v107, 0
    v_mov_b32 v108, 0
    v_mov_b32 v109, 0
    v_mov_b32 v110, 0
    v_mov_b32 v111, 0
    v_mov_b32 v112, 0
    v_mov_b32 v113, 0
    v_mov_b32 v114, 0
    v_mov_b32 v115, 0
    v_mov_b32 v116, 0
    v_mov_b32 v117, 0
    v_mov_b32 v118, 0
    v_mov_b32 v119, 0
    v_mov_b32 v120, 0
    v_mov_b32 v121, 0
    v_mov_b32 v122, 0
    v_mov_b32 v123, 0
    v_mov_b32 v124, 0
    v_mov_b32 v125, 0
    v_mov_b32 v126, 0
    v_mov_b32 v127, 0
    v_mov_b32 v128, 0
    v_mov_b32 v129, 0
    v_mov_b32 v130, 0
    v_mov_b32 v131, 0
    v_mov_b32 v132, 0
    v_mov_b32 v133, 0
    v_mov_b32 v134, 0
    v_mov_b32 v135, 0
    v_mov_b32 v136, 0
    v_mov_b32 v137, 0
    v_mov_b32 v138, 0
    v_mov_b32 v139, 0
    v_mov_b32 v140, 0
    v_mov_b32 v141, 0
    v_mov_b32 v142, 0
    v_mov_b32 v143, 0
    v_mov_b32 v144, 0
    v_mov_b32 v145, 0
    v_mov_b32 v146, 0
    v_mov_b32 v147, 0
    v_mov_b32 v148, 0
    v_mov_b32 v149, 0
    v_mov_b32 v150, 0
    v_mov_b32 v151, 0
    v_mov_b32 v152, 0
    v_mov_b32 v153, 0
    v_mov_b32 v154, 0
    v_mov_b32 v155, 0
    v_mov_b32 v156, 0
    v_mov_b32 v157, 0
    v_mov_b32 v158, 0
    v_mov_b32 v159, 0
    v_mov_b32 v160, 0
    v_mov_b32 v161, 0
    v_mov_b32 v162, 0
    v_mov_b32 v163, 0
    v_mov_b32 v164, 0
    v_mov_b32 v165, 0
    v_mov_b32 v166, 0
    v_mov_b32 v167, 0
    s_mul_i32 s30, s22, 4096
    s_mul_i32 s31, s22, 6144
    s_add_u32 s31, s31, 16384
    s_mov_b32 s29, s18
    s_add_u32 m0, s30, 0
    s_nop 0
    buffer_load_dwordx4 v8, s[4:7], s16 offen lds
    s_add_u32 m0, s30, 1024
    s_nop 0
    buffer_load_dwordx4 v9, s[4:7], s16 offen lds
    s_add_u32 m0, s30, 2048
    s_nop 0
    buffer_load_dwordx4 v10, s[4:7], s16 offen lds
    s_add_u32 m0, s30, 3072
    s_nop 0
    buffer_load_dwordx4 v11, s[4:7], s16 offen lds
    s_add_u32 m0, s31, 0
    s_nop 0
    buffer_load_dwordx4 v12, s[8:11], s17 offen lds
    s_add_u32 m0, s31, 1024
    s_nop 0
    buffer_load_dwordx4 v13, s[8:11], s17 offen lds
    s_add_u32 m0, s31, 2048
    s_nop 0
    buffer_load_dwordx4 v14, s[8:11], s17 offen lds
    s_add_u32 m0, s31, 3072
    s_nop 0
    buffer_load_dwordx4 v15, s[8:11], s17 offen lds
    s_add_u32 m0, s31, 4096
    s_nop 0
    buffer_load_dwordx4 v16, s[8:11], s17 offen lds
    s_add_u32 m0, s31, 5120
    s_nop 0
    buffer_load_dwordx4 v17, s[8:11], s17 offen lds
    s_add_u32 s16, s16, 128
    s_add_u32 s17, s17, s23
    s_sub_u32 s29, s29, 1
k3_kernel_loop:
    s_cmp_ge_u32 s18, 2
    s_cbranch_scc1 k3_kernel_w0
    s_waitcnt vmcnt(0)
k3_kernel_w0:
    s_waitcnt vmcnt(0)
    s_barrier
    ds_read_b128 v[32:35], v18 offset:0
    ds_read_b128 v[36:39], v18 offset:4096
    ds_read_b64_tr_b16 v[48:49], v26 offset:0
    ds_read_b64_tr_b16 v[50:51], v26 offset:1536
    ds_read_b64_tr_b16 v[52:53], v27 offset:0
    ds_read_b64_tr_b16 v[54:55], v27 offset:1536
    ds_read_b64_tr_b16 v[56:57], v28 offset:0
    ds_read_b64_tr_b16 v[58:59], v28 offset:1536
    s_cmp_eq_u32 s29, 0
    s_cbranch_scc1 k3_kernel_nd0
    s_add_u32 m0, s30, 40960
    s_nop 0
    buffer_load_dwordx4 v8, s[4:7], s16 offen lds
    s_add_u32 m0, s30, 41984
    s_nop 0
    buffer_load_dwordx4 v9, s[4:7], s16 offen lds
    s_add_u32 m0, s30, 43008
    s_nop 0
    buffer_load_dwordx4 v10, s[4:7], s16 offen lds
    s_add_u32 m0, s30, 44032
    s_nop 0
    buffer_load_dwordx4 v11, s[4:7], s16 offen lds
    s_add_u32 m0, s31, 40960
    s_nop 0
    buffer_load_dwordx4 v12, s[8:11], s17 offen lds
    s_add_u32 m0, s31, 41984
    s_nop 0
    buffer_load_dwordx4 v13, s[8:11], s17 offen lds
    s_add_u32 m0, s31, 43008
    s_nop 0
    buffer_load_dwordx4 v14, s[8:11], s17 offen lds
    s_add_u32 m0, s31, 44032
    s_nop 0
    buffer_load_dwordx4 v15, s[8:11], s17 offen lds
    s_add_u32 m0, s31, 45056
    s_nop 0
    buffer_load_dwordx4 v16, s[8:11], s17 offen lds
    s_add_u32 m0, s31, 46080
    s_nop 0
    buffer_load_dwordx4 v17, s[8:11], s17 offen lds
    s_add_u32 s16, s16, 128
    s_add_u32 s17, s17, s23
    s_sub_u32 s29, s29, 1
k3_kernel_nd0:
    ds_read_b128 v[40:43], v19 offset:0
    ds_read_b128 v[44:47], v19 offset:4096
    ds_read_b64_tr_b16 v[60:61], v26 offset:6144
    ds_read_b64_tr_b16 v[62:63], v26 offset:7680
    ds_read_b64_tr_b16 v[64:65], v27 offset:6144
    ds_read_b64_tr_b16 v[66:67], v27 offset:7680
    ds_read_b64_tr_b16 v[68:69], v28 offset:6144
    ds_read_b64_tr_b16 v[70:71], v28 offset:7680
    s_waitcnt lgkmcnt(8)
    v_mfma_f32_32x32x16_bf16 v[72:87], v[48:51], v[32:35], v[72:87]
    v_mfma_f32_32x32x16_bf16 v[88:103], v[52:55], v[32:35], v[88:103]
    v_mfma_f32_32x32x16_bf16 v[104:119], v[56:59], v[32:35], v[104:119]
    v_mfma_f32_32x32x16_bf16 v[120:135], v[48:51], v[36:39], v[120:135]
    v_mfma_f32_32x32x16_bf16 v[136:151], v[52:55], v[36:39], v[136:151]
    v_mfma_f32_32x32x16_bf16 v[152:167], v[56:59], v[36:39], v[152:167]
    ds_read_b128 v[32:35], v20 offset:0
    ds_read_b128 v[36:39], v20 offset:4096
    ds_read_b64_tr_b16 v[48:49], v26 offset:12288
    ds_read_b64_tr_b16 v[50:51], v26 offset:13824
    ds_read_b64_tr_b16 v[52:53], v27 offset:12288
    ds_read_b64_tr_b16 v[54:55], v27 offset:13824
    ds_read_b64_tr_b16 v[56:57], v28 offset:12288
    ds_read_b64_tr_b16 v[58:59], v28 offset:13824
    s_waitcnt lgkmcnt(8)
    v_mfma_f32_32x32x16_bf16 v[72:87], v[60:63], v[40:43], v[72:87]
    v_mfma_f32_32x32x16_bf16 v[88:103], v[64:67], v[40:43], v[88:103]
    v_mfma_f32_32x32x16_bf16 v[104:119], v[68:71], v[40:43], v[104:119]
    v_mfma_f32_32x32x16_bf16 v[120:135], v[60:63], v[44:47], v[120:135]
    v_mfma_f32_32x32x16_bf16 v[136:151], v[64:67], v[44:47], v[136:151]
    v_mfma_f32_32x32x16_bf16 v[152:167], v[68:71], v[44:47], v[152:167]
    ds_read_b128 v[40:43], v21 offset:0
    ds_read_b128 v[44:47], v21 offset:4096
    ds_read_b64_tr_b16 v[60:61], v26 offset:18432
    ds_read_b64_tr_b16 v[62:63], v26 offset:19968
    ds_read_b64_tr_b16 v[64:65], v27 offset:18432
    ds_read_b64_tr_b16 v[66:67], v27 offset:19968
    ds_read_b64_tr_b16 v[68:69], v28 offset:18432
    ds_read_b64_tr_b16 v[70:71], v28 offset:19968
    s_waitcnt lgkmcnt(8)
    v_mfma_f32_32x32x16_bf16 v[72:87], v[48:51], v[32:35], v[72:87]
    v_mfma_f32_32x32x16_bf16 v[88:103], v[52:55], v[32:35], v[88:103]
    v_mfma_f32_32x32x16_bf16 v[104:119], v[56:59], v[32:35], v[104:119]
    v_mfma_f32_32x32x16_bf16 v[120:135], v[48:51], v[36:39], v[120:135]
    v_mfma_f32_32x32x16_bf16 v[136:151], v[52:55], v[36:39], v[136:151]
    v_mfma_f32_32x32x16_bf16 v[152:167], v[56:59], v[36:39], v[152:167]
    s_waitcnt lgkmcnt(0)
    v_mfma_f32_32x32x16_bf16 v[72:87], v[60:63], v[40:43], v[72:87]
    v_mfma_f32_32x32x16_bf16 v[88:103], v[64:67], v[40:43], v[88:103]
    v_mfma_f32_32x32x16_bf16 v[104:119], v[68:71], v[40:43], v[104:119]
    v_mfma_f32_32x32x16_bf16 v[120:135], v[60:63], v[44:47], v[120:135]
    v_mfma_f32_32x32x16_bf16 v[136:151], v[64:67], v[44:47], v[136:151]
    v_mfma_f32_32x32x16_bf16 v[152:167], v[68:71], v[44:47], v[152:167]
    s_sub_u32 s18, s18, 1
    s_cmp_eq_u32 s18, 0
    s_cbranch_scc1 k3_kernel_done
    s_cmp_ge_u32 s18, 2
    s_cbranch_scc1 k3_kernel_w1
    s_waitcnt vmcnt(0)
k3_kernel_w1:
    s_waitcnt vmcnt(0)
    s_barrier
    ds_read_b128 v[32:35], v22 offset:0
    ds_read_b128 v[36:39], v22 offset:4096
    ds_read_b64_tr_b16 v[48:49], v29 offset:0
    ds_read_b64_tr_b16 v[50:51], v29 offset:1536
    ds_read_b64_tr_b16 v[52:53], v30 offset:0
    ds_read_b64_tr_b16 v[54:55], v30 offset:1536
    ds_read_b64_tr_b16 v[56:57], v31 offset:0
    ds_read_b64_tr_b16 v[58:59], v31 offset:1536
    s_cmp_eq_u32 s29, 0
    s_cbranch_scc1 k3_kernel_nd1
    s_add_u32 m0, s30, 0
    s_nop 0
    buffer_load_dwordx4 v8, s[4:7], s16 offen lds
    s_add_u32 m0, s30, 1024
    s_nop 0
    buffer_load_dwordx4 v9, s[4:7], s16 offen lds
    s_add_u32 m0, s30, 2048
    s_nop 0
    buffer_load_dwordx4 v10, s[4:7], s16 offen lds
    s_add_u32 m0, s30, 3072
    s_nop 0
    buffer_load_dwordx4 v11, s[4:7], s16 offen lds
    s_add_u32 m0, s31, 0
    s_nop 0
    buffer_load_dwordx4 v12, s[8:11], s17 offen lds
    s_add_u32 m0, s31, 1024
    s_nop 0
    buffer_load_dwordx4 v13, s[8:11], s17 offen lds
    s_add_u32 m0, s31, 2048
    s_nop 0
    buffer_load_dwordx4 v14, s[8:11], s17 offen lds
    s_add_u32 m0, s31, 3072
    s_nop 0
    buffer_load_dwordx4 v15, s[8:11], s17 offen lds
    s_add_u32 m0, s31, 4096
    s_nop 0
    buffer_load_dwordx4 v16, s[8:11], s17 offen lds
    s_add_u32 m0, s31, 5120
    s_nop 0
    buffer_load_dwordx4 v17, s[8:11], s17 offen lds
    s_add_u32 s16, s16, 128
    s_add_u32 s17, s17, s23
    s_sub_u32 s29, s29, 1
k3_kernel_nd1:
    ds_read_b128 v[40:43], v23 offset:0
    ds_read_b128 v[44:47], v23 offset:4096
    ds_read_b64_tr_b16 v[60:61], v29 offset:6144
    ds_read_b64_tr_b16 v[62:63], v29 offset:7680
    ds_read_b64_tr_b16 v[64:65], v30 offset:6144
    ds_read_b64_tr_b16 v[66:67], v30 offset:7680
    ds_read_b64_tr_b16 v[68:69], v31 offset:6144
    ds_read_b64_tr_b16 v[70:71], v31 offset:7680
    s_waitcnt lgkmcnt(8)
    v_mfma_f32_32x32x16_bf16 v[72:87], v[48:51], v[32:35], v[72:87]
    v_mfma_f32_32x32x16_bf16 v[88:103], v[52:55], v[32:35], v[88:103]
    v_mfma_f32_32x32x16_bf16 v[104:119], v[56:59], v[32:35], v[104:119]
    v_mfma_f32_32x32x16_bf16 v[120:135], v[48:51], v[36:39], v[120:135]
    v_mfma_f32_32x32x16_bf16 v[136:151], v[52:55], v[36:39], v[136:151]
    v_mfma_f32_32x32x16_bf16 v[152:167], v[56:59], v[36:39], v[152:167]
    ds_read_b128 v[32:35], v24 offset:0
    ds_read_b128 v[36:39], v24 offset:4096
    ds_read_b64_tr_b16 v[48:49], v29 offset:12288
    ds_read_b64_tr_b16 v[50:51], v29 offset:13824
    ds_read_b64_tr_b16 v[52:53], v30 offset:12288
    ds_read_b64_tr_b16 v[54:55], v30 offset:13824
    ds_read_b64_tr_b16 v[56:57], v31 offset:12288
    ds_read_b64_tr_b16 v[58:59], v31 offset:13824
    s_waitcnt lgkmcnt(8)
    v_mfma_f32_32x32x16_bf16 v[72:87], v[60:63], v[40:43], v[72:87]
    v_mfma_f32_32x32x16_bf16 v[88:103], v[64:67], v[40:43], v[88:103]
    v_mfma_f32_32x32x16_bf16 v[104:119], v[68:71], v[40:43], v[104:119]
    v_mfma_f32_32x32x16_bf16 v[120:135], v[60:63], v[44:47], v[120:135]
    v_mfma_f32_32x32x16_bf16 v[136:151], v[64:67], v[44:47], v[136:151]
    v_mfma_f32_32x32x16_bf16 v[152:167], v[68:71], v[44:47], v[152:167]
    ds_read_b128 v[40:43], v25 offset:0
    ds_read_b128 v[44:47], v25 offset:4096
    ds_read_b64_tr_b16 v[60:61], v29 offset:18432
    ds_read_b64_tr_b16 v[62:63], v29 offset:19968
    ds_read_b64_tr_b16 v[64:65], v30 offset:18432
    ds_read_b64_tr_b16 v[66:67], v30 offset:19968
    ds_read_b64_tr_b16 v[68:69], v31 offset:18432
    ds_read_b64_tr_b16 v[70:71], v31 offset:19968
    s_waitcnt lgkmcnt(8)
    v_mfma_f32_32x32x16_bf16 v[72:87], v[48:51], v[32:35], v[72:87]
    v_mfma_f32_32x32x16_bf16 v[88:103], v[52:55], v[32:35], v[88:103]
    v_mfma_f32_32x32x16_bf16 v[104:119], v[56:59], v[32:35], v[104:119]
    v_mfma_f32_32x32x16_bf16 v[120:135], v[48:51], v[36:39], v[120:135]
    v_mfma_f32_32x32x16_bf16 v[136:151], v[52:55], v[36:39], v[136:151]
    v_mfma_f32_32x32x16_bf16 v[152:167], v[56:59], v[36:39], v[152:167]
    s_waitcnt lgkmcnt(0)
    v_mfma_f32_32x32x16_bf16 v[72:87], v[60:63], v[40:43], v[72:87]
    v_mfma_f32_32x32x16_bf16 v[88:103], v[64:67], v[40:43], v[88:103]
    v_mfma_f32_32x32x16_bf16 v[104:119], v[68:71], v[40:43], v[104:119]
    v_mfma_f32_32x32x16_bf16 v[120:135], v[60:63], v[44:47], v[120:135]
    v_mfma_f32_32x32x16_bf16 v[136:151], v[64:67], v[44:47], v[136:151]
    v_mfma_f32_32x32x16_bf16 v[152:167], v[68:71], v[44:47], v[152:167]
    s_sub_u32 s18, s18, 1
    s_cmp_eq_u32 s18, 0
    s_cbranch_scc1 k3_kernel_done
    s_branch k3_kernel_loop
k3_kernel_done:
    s_nop 15
    v_and_b32 v3, 31, v1
    v_lshrrev_b32 v4, 1, v2
    v_mul_u32_u24 v4, 64, v4
    v_add_u32 v3, v3, v4
    v_mul_lo_u32 v3, v3, s21
    v_and_b32 v4, 1, v2
    v_mul_u32_u24 v4, 384, v4
    v_add_u32 v3, v3, v4
    v_lshrrev_b32 v4, 5, v1
    v_lshl_add_u32 v3, v4, 4, v3
    s_lshl_b32 s26, s21, 5
    s_mov_b32 s25, s28
    buffer_store_dwordx4 v[72:75], v3, s[12:15], s25 offen offset:0
    buffer_store_dwordx4 v[76:79], v3, s[12:15], s25 offen offset:32
    buffer_store_dwordx4 v[80:83], v3, s[12:15], s25 offen offset:64
    buffer_store_dwordx4 v[84:87], v3, s[12:15], s25 offen offset:96
    buffer_store_dwordx4 v[88:91], v3, s[12:15], s25 offen offset:128
    buffer_store_dwordx4 v[92:95], v3, s[12:15], s25 offen offset:160
    buffer_store_dwordx4 v[96:99], v3, s[12:15], s25 offen offset:192
    buffer_store_dwordx4 v[100:103], v3, s[12:15], s25 offen offset:224
    buffer_store_dwordx4 v[104:107], v3, s[12:15], s25 offen offset:256
    buffer_store_dwordx4 v[108:111], v3, s[12:15], s25 offen offset:288
    buffer_store_dwordx4 v[112:115], v3, s[12:15], s25 offen offset:320
    buffer_store_dwordx4 v[116:119], v3, s[12:15], s25 offen offset:352
    s_add_u32 s25, s25, s26
    buffer_store_dwordx4 v[120:123], v3, s[12:15], s25 offen offset:0
    buffer_store_dwordx4 v[124:127], v3, s[12:15], s25 offen offset:32
    buffer_store_dwordx4 v[128:131], v3, s[12:15], s25 offen offset:64
    buffer_store_dwordx4 v[132:135], v3, s[12:15], s25 offen offset:96
    buffer_store_dwordx4 v[136:139], v3, s[12:15], s25 offen offset:128
    buffer_store_dwordx4 v[140:143], v3, s[12:15], s25 offen offset:160
    buffer_store_dwordx4 v[144:147], v3, s[12:15], s25 offen offset:192
    buffer_store_dwordx4 v[148:151], v3, s[12:15], s25 offen offset:224
    buffer_store_dwordx4 v[152:155], v3, s[12:15], s25 offen offset:256
    buffer_store_dwordx4 v[156:159], v3, s[12:15], s25 offen offset:288
    buffer_store_dwordx4 v[160:163], v3, s[12:15], s25 offen offset:320
    buffer_store_dwordx4 v[164:167], v3, s[12:15], s25 offen offset:352
    s_waitcnt vmcnt(0)
k3_kernel_end:
    s_endpgm
.section .rodata,"a"
.p2align 6
.amdhsa_kernel k3_kernel
  .amdhsa_next_free_vgpr 168
  .amdhsa_next_free_sgpr 102
  .amdhsa_accum_offset 168
  .amdhsa_group_segment_fixed_size 0
  .amdhsa_kernarg_size 104
  .amdhsa_user_sgpr_count 2
  .amdhsa_user_sgpr_kernarg_segment_ptr 1
  .amdhsa_system_sgpr_workgroup_id_x 1
.end_amdhsa_kernel
.text
.globl k4_kernel
.p2align 8
.type k4_kernel,@function
k4_kernel:
    s_cmp_ge_u32 s2, 512
    s_cbranch_scc1 k4_kernel_end
    s_load_dwordx2 s[32:33], s[0:1], 96
    s_load_dwordx2 s[26:27], s[0:1], 0
    s_load_dwordx2 s[28:29], s[0:1], 72
    s_load_dwordx2 s[30:31], s[0:1], 80
    s_waitcnt lgkmcnt(0)
    s_mov_b32 s4, s26
    s_mov_b32 s5, s27
    s_mov_b32 s6, 2359296
    s_mov_b32 s7, 0x00020000
    s_mov_b32 s8, s28
    s_mov_b32 s9, s29
    s_mov_b32 s10, 1152
    s_mov_b32 s11, 0x00020000
    s_mov_b32 s12, s30
    s_mov_b32 s13, s31
    s_mov_b32 s14, 2359296
    s_mov_b32 s15, 0x00020000
    s_add_u32 s16, s32, 100663296
    s_addc_u32 s17, s33, 0
    s_mov_b32 s18, 23592960
    s_mov_b32 s19, 0x00020000
    v_and_b32 v1, 63, v0
    v_lshrrev_b32 v2, 6, v0
    s_lshl_b32 s20, s2, 2
    v_add_u32 v2, s20, v2
    v_mul_u32_u24 v3, 1152, v2
    v_lshl_add_u32 v3, v1, 1, v3
    v_lshlrev_b32 v4, 1, v1
    buffer_load_ushort v8, v3, s[4:7], 0 offen offset:0
    buffer_load_ushort v20, v4, s[8:11], 0 offen offset:0
    buffer_load_ushort v9, v3, s[4:7], 0 offen offset:128
    buffer_load_ushort v21, v4, s[8:11], 0 offen offset:128
    buffer_load_ushort v10, v3, s[4:7], 0 offen offset:256
    buffer_load_ushort v22, v4, s[8:11], 0 offen offset:256
    buffer_load_ushort v11, v3, s[4:7], 0 offen offset:384
    buffer_load_ushort v23, v4, s[8:11], 0 offen offset:384
    buffer_load_ushort v12, v3, s[4:7], 0 offen offset:512
    buffer_load_ushort v24, v4, s[8:11], 0 offen offset:512
    buffer_load_ushort v13, v3, s[4:7], 0 offen offset:640
    buffer_load_ushort v25, v4, s[8:11], 0 offen offset:640
    buffer_load_ushort v14, v3, s[4:7], 0 offen offset:768
    buffer_load_ushort v26, v4, s[8:11], 0 offen offset:768
    buffer_load_ushort v15, v3, s[4:7], 0 offen offset:896
    buffer_load_ushort v27, v4, s[8:11], 0 offen offset:896
    buffer_load_ushort v16, v3, s[4:7], 0 offen offset:1024
    buffer_load_ushort v28, v4, s[8:11], 0 offen offset:1024
    v_mul_u32_u24 v5, 2304, v2
    v_lshl_add_u32 v5, v1, 2, v5
    s_mov_b32 s21, 0
    buffer_load_dword v32, v5, s[16:19], s21 offen offset:0
    buffer_load_dword v33, v5, s[16:19], s21 offen offset:256
    buffer_load_dword v34, v5, s[16:19], s21 offen offset:512
    buffer_load_dword v35, v5, s[16:19], s21 offen offset:768
    buffer_load_dword v36, v5, s[16:19], s21 offen offset:1024
    buffer_load_dword v37, v5, s[16:19], s21 offen offset:1280
    buffer_load_dword v38, v5, s[16:19], s21 offen offset:1536
    buffer_load_dword v39, v5, s[16:19], s21 offen offset:1792
    buffer_load_dword v40, v5, s[16:19], s21 offen offset:2048
    s_mov_b32 s21, 4718592
    buffer_load_dword v41, v5, s[16:19], s21 offen offset:0
    buffer_load_dword v42, v5, s[16:19], s21 offen offset:256
    buffer_load_dword v43, v5, s[16:19], s21 offen offset:512
    buffer_load_dword v44, v5, s[16:19], s21 offen offset:768
    buffer_load_dword v45, v5, s[16:19], s21 offen offset:1024
    buffer_load_dword v46, v5, s[16:19], s21 offen offset:1280
    buffer_load_dword v47, v5, s[16:19], s21 offen offset:1536
    buffer_load_dword v48, v5, s[16:19], s21 offen offset:1792
    buffer_load_dword v49, v5, s[16:19], s21 offen offset:2048
    s_mov_b32 s21, 9437184
    buffer_load_dword v50, v5, s[16:19], s21 offen offset:0
    buffer_load_dword v51, v5, s[16:19], s21 offen offset:256
    buffer_load_dword v52, v5, s[16:19], s21 offen offset:512
    buffer_load_dword v53, v5, s[16:19], s21 offen offset:768
    buffer_load_dword v54, v5, s[16:19], s21 offen offset:1024
    buffer_load_dword v55, v5, s[16:19], s21 offen offset:1280
    buffer_load_dword v56, v5, s[16:19], s21 offen offset:1536
    buffer_load_dword v57, v5, s[16:19], s21 offen offset:1792
    buffer_load_dword v58, v5, s[16:19], s21 offen offset:2048
    s_mov_b32 s21, 14155776
    buffer_load_dword v59, v5, s[16:19], s21 offen offset:0
    buffer_load_dword v60, v5, s[16:19], s21 offen offset:256
    buffer_load_dword v61, v5, s[16:19], s21 offen offset:512
    buffer_load_dword v62, v5, s[16:19], s21 offen offset:768
    buffer_load_dword v63, v5, s[16:19], s21 offen offset:1024
    buffer_load_dword v64, v5, s[16:19], s21 offen offset:1280
    buffer_load_dword v65, v5, s[16:19], s21 offen offset:1536
    buffer_load_dword v66, v5, s[16:19], s21 offen offset:1792
    buffer_load_dword v67, v5, s[16:19], s21 offen offset:2048
    s_mov_b32 s21, 18874368
    buffer_load_dword v68, v5, s[16:19], s21 offen offset:0
    buffer_load_dword v69, v5, s[16:19], s21 offen offset:256
    buffer_load_dword v70, v5, s[16:19], s21 offen offset:512
    buffer_load_dword v71, v5, s[16:19], s21 offen offset:768
    buffer_load_dword v72, v5, s[16:19], s21 offen offset:1024
    buffer_load_dword v73, v5, s[16:19], s21 offen offset:1280
    buffer_load_dword v74, v5, s[16:19], s21 offen offset:1536
    buffer_load_dword v75, v5, s[16:19], s21 offen offset:1792
    buffer_load_dword v76, v5, s[16:19], s21 offen offset:2048
    s_waitcnt vmcnt(45)
    v_mov_b32 v6, 0
    v_lshlrev_b32 v8, 16, v8
    v_lshlrev_b32 v20, 16, v20
    v_mul_f32 v8, v8, v20
    v_cvt_pk_bf16_f32 v8, v8, v8
    v_lshlrev_b32 v8, 16, v8
    v_add_f32 v6, v6, v8
    v_lshlrev_b32 v9, 16, v9
    v_lshlrev_b32 v21, 16, v21
    v_mul_f32 v9, v9, v21
    v_cvt_pk_bf16_f32 v9, v9, v9
    v_lshlrev_b32 v9, 16, v9
    v_add_f32 v6, v6, v9
    v_lshlrev_b32 v10, 16, v10
    v_lshlrev_b32 v22, 16, v22
    v_mul_f32 v10, v10, v22
    v_cvt_pk_bf16_f32 v10, v10, v10
    v_lshlrev_b32 v10, 16, v10
    v_add_f32 v6, v6, v10
    v_lshlrev_b32 v11, 16, v11
    v_lshlrev_b32 v23, 16, v23
    v_mul_f32 v11, v11, v23
    v_cvt_pk_bf16_f32 v11, v11, v11
    v_lshlrev_b32 v11, 16, v11
    v_add_f32 v6, v6, v11
    v_lshlrev_b32 v12, 16, v12
    v_lshlrev_b32 v24, 16, v24
    v_mul_f32 v12, v12, v24
    v_cvt_pk_bf16_f32 v12, v12, v12
    v_lshlrev_b32 v12, 16, v12
    v_add_f32 v6, v6, v12
    v_lshlrev_b32 v13, 16, v13
    v_lshlrev_b32 v25, 16, v25
    v_mul_f32 v13, v13, v25
    v_cvt_pk_bf16_f32 v13, v13, v13
    v_lshlrev_b32 v13, 16, v13
    v_add_f32 v6, v6, v13
    v_lshlrev_b32 v14, 16, v14
    v_lshlrev_b32 v26, 16, v26
    v_mul_f32 v14, v14, v26
    v_cvt_pk_bf16_f32 v14, v14, v14
    v_lshlrev_b32 v14, 16, v14
    v_add_f32 v6, v6, v14
    v_lshlrev_b32 v15, 16, v15
    v_lshlrev_b32 v27, 16, v27
    v_mul_f32 v15, v15, v27
    v_cvt_pk_bf16_f32 v15, v15, v15
    v_lshlrev_b32 v15, 16, v15
    v_add_f32 v6, v6, v15
    v_lshlrev_b32 v16, 16, v16
    v_lshlrev_b32 v28, 16, v28
    v_mul_f32 v16, v16, v28
    v_cvt_pk_bf16_f32 v16, v16, v16
    v_lshlrev_b32 v16, 16, v16
    v_add_f32 v6, v6, v16
    ds_swizzle_b32 v7, v6 offset:0x041f
    s_waitcnt lgkmcnt(0)
    v_add_f32 v6, v6, v7
    ds_swizzle_b32 v7, v6 offset:0x081f
    s_waitcnt lgkmcnt(0)
    v_add_f32 v6, v6, v7
    ds_swizzle_b32 v7, v6 offset:0x101f
    s_waitcnt lgkmcnt(0)
    v_add_f32 v6, v6, v7
    ds_swizzle_b32 v7, v6 offset:0x201f
    s_waitcnt lgkmcnt(0)
    v_add_f32 v6, v6, v7
    ds_swizzle_b32 v7, v6 offset:0x401f
    s_waitcnt lgkmcnt(0)
    v_add_f32 v6, v6, v7
    v_mov_b32 v7, v6
    s_nop 1
    v_permlane32_swap_b32 v6, v7
    s_nop 1
    v_add_f32 v6, v6, v7
    v_cvt_pk_bf16_f32 v6, v6, v6
    v_lshlrev_b32 v6, 16, v6
    v_mul_f32 v6, 0xbfb8aa3b, v6
    v_exp_f32 v6, v6
    s_nop 0
    v_add_f32 v6, 1.0, v6
    v_rcp_f32 v6, v6
    s_nop 0
    v_cvt_pk_bf16_f32 v6, v6, v6
    v_lshlrev_b32 v6, 16, v6
    v_sub_f32 v7, 1.0, v6
    v_cvt_pk_bf16_f32 v7, v7, v7
    v_lshlrev_b32 v7, 16, v7
    s_waitcnt vmcnt(0)
    v_mul_u32_u24 v3, 1152, v2
    v_lshl_add_u32 v3, v1, 1, v3
    v_add_f32 v32, v32, v41
    v_add_f32 v50, v50, v59
    v_add_f32 v50, v50, v68
    v_cvt_pk_bf16_f32 v32, v32, v32
    v_lshlrev_b32 v32, 16, v32
    v_cvt_pk_bf16_f32 v50, v50, v50
    v_lshlrev_b32 v50, 16, v50
    v_mul_f32 v32, v32, v6
    v_mul_f32 v50, v50, v7
    v_cvt_pk_bf16_f32 v32, v32, v32
    v_lshlrev_b32 v32, 16, v32
    v_cvt_pk_bf16_f32 v50, v50, v50
    v_lshlrev_b32 v50, 16, v50
    v_add_f32 v32, v32, v50
    v_cvt_pk_bf16_f32 v32, v32, v32
    buffer_store_short v32, v3, s[12:15], 0 offen offset:0
    v_add_f32 v33, v33, v42
    v_add_f32 v51, v51, v60
    v_add_f32 v51, v51, v69
    v_cvt_pk_bf16_f32 v33, v33, v33
    v_lshlrev_b32 v33, 16, v33
    v_cvt_pk_bf16_f32 v51, v51, v51
    v_lshlrev_b32 v51, 16, v51
    v_mul_f32 v33, v33, v6
    v_mul_f32 v51, v51, v7
    v_cvt_pk_bf16_f32 v33, v33, v33
    v_lshlrev_b32 v33, 16, v33
    v_cvt_pk_bf16_f32 v51, v51, v51
    v_lshlrev_b32 v51, 16, v51
    v_add_f32 v33, v33, v51
    v_cvt_pk_bf16_f32 v33, v33, v33
    buffer_store_short v33, v3, s[12:15], 0 offen offset:128
    v_add_f32 v34, v34, v43
    v_add_f32 v52, v52, v61
    v_add_f32 v52, v52, v70
    v_cvt_pk_bf16_f32 v34, v34, v34
    v_lshlrev_b32 v34, 16, v34
    v_cvt_pk_bf16_f32 v52, v52, v52
    v_lshlrev_b32 v52, 16, v52
    v_mul_f32 v34, v34, v6
    v_mul_f32 v52, v52, v7
    v_cvt_pk_bf16_f32 v34, v34, v34
    v_lshlrev_b32 v34, 16, v34
    v_cvt_pk_bf16_f32 v52, v52, v52
    v_lshlrev_b32 v52, 16, v52
    v_add_f32 v34, v34, v52
    v_cvt_pk_bf16_f32 v34, v34, v34
    buffer_store_short v34, v3, s[12:15], 0 offen offset:256
    v_add_f32 v35, v35, v44
    v_add_f32 v53, v53, v62
    v_add_f32 v53, v53, v71
    v_cvt_pk_bf16_f32 v35, v35, v35
    v_lshlrev_b32 v35, 16, v35
    v_cvt_pk_bf16_f32 v53, v53, v53
    v_lshlrev_b32 v53, 16, v53
    v_mul_f32 v35, v35, v6
    v_mul_f32 v53, v53, v7
    v_cvt_pk_bf16_f32 v35, v35, v35
    v_lshlrev_b32 v35, 16, v35
    v_cvt_pk_bf16_f32 v53, v53, v53
    v_lshlrev_b32 v53, 16, v53
    v_add_f32 v35, v35, v53
    v_cvt_pk_bf16_f32 v35, v35, v35
    buffer_store_short v35, v3, s[12:15], 0 offen offset:384
    v_add_f32 v36, v36, v45
    v_add_f32 v54, v54, v63
    v_add_f32 v54, v54, v72
    v_cvt_pk_bf16_f32 v36, v36, v36
    v_lshlrev_b32 v36, 16, v36
    v_cvt_pk_bf16_f32 v54, v54, v54
    v_lshlrev_b32 v54, 16, v54
    v_mul_f32 v36, v36, v6
    v_mul_f32 v54, v54, v7
    v_cvt_pk_bf16_f32 v36, v36, v36
    v_lshlrev_b32 v36, 16, v36
    v_cvt_pk_bf16_f32 v54, v54, v54
    v_lshlrev_b32 v54, 16, v54
    v_add_f32 v36, v36, v54
    v_cvt_pk_bf16_f32 v36, v36, v36
    buffer_store_short v36, v3, s[12:15], 0 offen offset:512
    v_add_f32 v37, v37, v46
    v_add_f32 v55, v55, v64
    v_add_f32 v55, v55, v73
    v_cvt_pk_bf16_f32 v37, v37, v37
    v_lshlrev_b32 v37, 16, v37
    v_cvt_pk_bf16_f32 v55, v55, v55
    v_lshlrev_b32 v55, 16, v55
    v_mul_f32 v37, v37, v6
    v_mul_f32 v55, v55, v7
    v_cvt_pk_bf16_f32 v37, v37, v37
    v_lshlrev_b32 v37, 16, v37
    v_cvt_pk_bf16_f32 v55, v55, v55
    v_lshlrev_b32 v55, 16, v55
    v_add_f32 v37, v37, v55
    v_cvt_pk_bf16_f32 v37, v37, v37
    buffer_store_short v37, v3, s[12:15], 0 offen offset:640
    v_add_f32 v38, v38, v47
    v_add_f32 v56, v56, v65
    v_add_f32 v56, v56, v74
    v_cvt_pk_bf16_f32 v38, v38, v38
    v_lshlrev_b32 v38, 16, v38
    v_cvt_pk_bf16_f32 v56, v56, v56
    v_lshlrev_b32 v56, 16, v56
    v_mul_f32 v38, v38, v6
    v_mul_f32 v56, v56, v7
    v_cvt_pk_bf16_f32 v38, v38, v38
    v_lshlrev_b32 v38, 16, v38
    v_cvt_pk_bf16_f32 v56, v56, v56
    v_lshlrev_b32 v56, 16, v56
    v_add_f32 v38, v38, v56
    v_cvt_pk_bf16_f32 v38, v38, v38
    buffer_store_short v38, v3, s[12:15], 0 offen offset:768
    v_add_f32 v39, v39, v48
    v_add_f32 v57, v57, v66
    v_add_f32 v57, v57, v75
    v_cvt_pk_bf16_f32 v39, v39, v39
    v_lshlrev_b32 v39, 16, v39
    v_cvt_pk_bf16_f32 v57, v57, v57
    v_lshlrev_b32 v57, 16, v57
    v_mul_f32 v39, v39, v6
    v_mul_f32 v57, v57, v7
    v_cvt_pk_bf16_f32 v39, v39, v39
    v_lshlrev_b32 v39, 16, v39
    v_cvt_pk_bf16_f32 v57, v57, v57
    v_lshlrev_b32 v57, 16, v57
    v_add_f32 v39, v39, v57
    v_cvt_pk_bf16_f32 v39, v39, v39
    buffer_store_short v39, v3, s[12:15], 0 offen offset:896
    v_add_f32 v40, v40, v49
    v_add_f32 v58, v58, v67
    v_add_f32 v58, v58, v76
    v_cvt_pk_bf16_f32 v40, v40, v40
    v_lshlrev_b32 v40, 16, v40
    v_cvt_pk_bf16_f32 v58, v58, v58
    v_lshlrev_b32 v58, 16, v58
    v_mul_f32 v40, v40, v6
    v_mul_f32 v58, v58, v7
    v_cvt_pk_bf16_f32 v40, v40, v40
    v_lshlrev_b32 v40, 16, v40
    v_cvt_pk_bf16_f32 v58, v58, v58
    v_lshlrev_b32 v58, 16, v58
    v_add_f32 v40, v40, v58
    v_cvt_pk_bf16_f32 v40, v40, v40
    buffer_store_short v40, v3, s[12:15], 0 offen offset:1024
    s_waitcnt vmcnt(0)
k4_kernel_end:
    s_endpgm
.section .rodata,"a"
.p2align 6
.amdhsa_kernel k4_kernel
  .amdhsa_next_free_vgpr 80
  .amdhsa_next_free_sgpr 102
  .amdhsa_accum_offset 80
  .amdhsa_group_segment_fixed_size 0
  .amdhsa_kernarg_size 104
  .amdhsa_user_sgpr_count 2
  .amdhsa_user_sgpr_kernarg_segment_ptr 1
  .amdhsa_system_sgpr_workgroup_id_x 1
.end_amdhsa_kernel
.text
```
